```python
import torch

def _softmax(x, axis=-1):
    return torch.softmax(x, dim=axis)
def _gelu(x):
    return torch.nn.functional.gelu(x, approximate="tanh")
def _silu(x):
    return torch.nn.functional.silu(x)
def _sigmoid(x):
    return torch.sigmoid(x)
def _layernorm(x, axis=-1, eps=1e-5):
    m = x.mean(dim=axis, keepdim=True)
    v = x.var(dim=axis, keepdim=True, unbiased=False)
    return (x - m) / torch.sqrt(v + eps)
def _scatter_add(tgt, idx, src, axis=0):
    return tgt.clone().index_add_(axis, idx, src)
def _segment_sum(src, seg, n):
    out = torch.zeros((n,) + src.shape[1:], dtype=src.dtype)
    return out.index_add_(0, seg, src)
def _pad(x, pw):
    flat = tuple(v for pair in reversed(pw) for v in pair)
    return torch.nn.functional.pad(x, flat)

kernel_name = 'concat_heads__mha_block__ssm_conv_s4__prompt'

def setup_inputs():

    _w = (lambda a: (lambda t: t.to(torch.bfloat16) if t.is_floating_point() else t)(torch.as_tensor(a)))
    def _A_setup():
        B, S, D, H = 1, 2048, 448, 16
        return {
            "x": _w((lambda *s: torch.randn(*s, dtype=torch.bfloat16) * 0.2)(B, S, D)),
            "wqkv": _w((lambda *s: torch.randn(*s, dtype=torch.bfloat16) * 0.2)(D, 3 * D)),
            "wo": _w((lambda *s: torch.randn(*s, dtype=torch.bfloat16) * 0.05)(D, D)),
        }
    _A_in = _A_setup()

    def _B_setup():
        B, L, D, N = 1, 2048, 448, 256
        A_re = -(lambda _x: torch.exp(torch.as_tensor(_x)))((lambda *s: torch.randn(*s, dtype=torch.bfloat16) * 3.2)(D, N))
        A_im = torch.pi * (lambda *s: torch.randn(*s, dtype=torch.bfloat16) * 0.05)(D, N)
        B_re = (lambda *s: torch.randn(*s, dtype=torch.bfloat16) * 0.2)(D, N)
        B_im = (lambda *s: torch.randn(*s, dtype=torch.bfloat16) * 0.2)(D, N)
        C_re = (lambda *s: torch.randn(*s, dtype=torch.bfloat16) * 0.2)(D, N)
        C_im = (lambda *s: torch.randn(*s, dtype=torch.bfloat16) * 0.2)(D, N)
        log_dt = (lambda *s: torch.randn(*s, dtype=torch.bfloat16) * 0.05)(D) * 0.5 - 4.0
        Dskip = (lambda *s: torch.randn(*s, dtype=torch.bfloat16) * 0.1)(D)
        return {
            "u": _w((lambda *s: torch.randn(*s, dtype=torch.bfloat16) * 0.05)(B, L, D)),
            "A_re": _w(A_re),
            "A_im": _w(A_im),
            "B_re": _w(B_re),
            "B_im": _w(B_im),
            "C_re": _w(C_re),
            "C_im": _w(C_im),
            "log_dt": _w(log_dt),
            "Dskip": _w(Dskip),
        }
    _B_in = _B_setup()

    return {
        "A_x": _A_in["x"],
        "A_wqkv": _A_in["wqkv"],
        "A_wo": _A_in["wo"],
        "B_u": _B_in["u"],
        "B_A_re": _B_in["A_re"],
        "B_A_im": _B_in["A_im"],
        "B_B_re": _B_in["B_re"],
        "B_B_im": _B_in["B_im"],
        "B_C_re": _B_in["C_re"],
        "B_C_im": _B_in["C_im"],
        "B_log_dt": _B_in["log_dt"],
        "B_Dskip": _B_in["Dskip"],
    }

def reference(A_x, A_wqkv, A_wo, B_u, B_A_re, B_A_im, B_B_re, B_B_im, B_C_re, B_C_im, B_log_dt, B_Dskip):
    def _A_ref(x, wqkv, wo):
        B, S, D = x.shape
        H = 16
        Dh = D // H
        qkv = (lambda x, *d: x.permute(*d))((x @ wqkv).reshape(B, S, 3, H, Dh), 2, 0, 3, 1, 4)
        q, k, v = qkv[0], qkv[1], qkv[2]
        scores = torch.einsum("bhqd,bhkd->bhqk", q, k) * (Dh ** -0.5)
        p = _softmax(scores, axis=-1)
        o = torch.einsum("bhqk,bhkd->bhqd", p, v)
        return (lambda x, *d: x.permute(*d))(o, 0, 2, 1, 3).reshape(B, S, D) @ wo

    def _B_ref(u, A_re, A_im, B_re, B_im, C_re, C_im, log_dt, Dskip):
        Bsz, L, D = u.shape
        dt = torch.exp(log_dt)[:, None]
        A = A_re + 1j * A_im
        Bc = B_re + 1j * B_im
        Cc = C_re + 1j * C_im
        logdA = dt * A
        dB = dt * Bc
        l = (lambda x, dt: x.to(dt))(torch.arange(L), A_re.dtype)
        P = torch.exp(logdA[:, :, None] * l[None, None, :])
        K = torch.einsum("dn,dnl,dn->dl", Cc, P, dB).real
        L2 = 2 * L
        Kp = _pad(K, ((0, 0), (0, L)))
        up = (lambda x, *d: x.permute(*d))(u, 0, 2, 1)
        up = _pad(up, ((0, 0), (0, 0), (0, L)))
        Kf = (lambda x, axes=(-2,-1): torch.fft.rfft2(x.float(), dim=axes))(Kp[:, None, :], axes=(-2, -1))
        Uf = (lambda x, axes=(-2,-1): torch.fft.rfft2(x.float(), dim=axes))(up[:, :, None, :], axes=(-2, -1))
        Yf = Uf * Kf[None, :, :, :]
        y = (lambda x, s, axes=(-2,-1): torch.fft.irfft2(x, s=s, dim=axes).to(torch.bfloat16))(Yf, (1, L2), axes=(-2, -1))[:, :, 0, :L]
        y = (lambda x, *d: x.permute(*d))(y, 0, 2, 1) + u * Dskip[None, None, :]
        return y

    a = _A_ref(A_x, A_wqkv, A_wo)
    b = _B_ref(B_u, B_A_re, B_A_im, B_B_re, B_B_im, B_C_re, B_C_im, B_log_dt, B_Dskip)
    return torch.concatenate([a, b], axis=-1)
```

```asm
; @launch grid=(256,1,1) block=(576,1,1) lds=161792
.amdgcn_target "amdgcn-amd-amdhsa--gfx950"
.text
.globl concat_heads__mha_block__ssm_conv_s4__prompt_kernel
.p2align 8
.type concat_heads__mha_block__ssm_conv_s4__prompt_kernel,@function
concat_heads__mha_block__ssm_conv_s4__prompt_kernel:
    s_cmp_ge_u32 s2, 224
    s_cbranch_scc1 k1_aux
    v_lshrrev_b32 v1, 6, v0
    v_and_b32 v0, 63, v0
    v_readfirstlane_b32 s3, v1
    v_lshlrev_b32 v1, 2, v0
    s_cmp_eq_u32 s3, 8
    s_cbranch_scc0 k1_nz
    v_and_b32 v2, 60, v1
    v_add_u32 v2, 160000, v2
    v_mov_b32 v3, 0
    ds_write_b32 v2, v3
    ds_write_b32 v1, v3
    s_waitcnt lgkmcnt(0)
k1_nz:
    s_load_dwordx16 s[36:51], s[0:1], 0
    s_load_dwordx8 s[52:59], s[0:1], 64
    s_load_dwordx2 s[60:61], s[0:1], 112
    s_and_b32 s6, s2, 7
    s_lshr_b32 s7, s2, 3
    s_and_b32 s4, s6, 1
    s_mul_i32 s4, s4, 7
    s_lshr_b32 s20, s7, 2
    s_add_u32 s4, s4, s20
    s_lshr_b32 s5, s6, 1
    s_lshl_b32 s5, s5, 2
    s_and_b32 s20, s7, 3
    s_add_u32 s5, s5, s20
    s_lshl_b32 s35, s20, 1
    s_lshr_b32 s20, s7, 2
    s_add_u32 s35, s35, s20
    s_sub_u32 s20, s35, 7
    s_cmp_ge_u32 s35, 7
    s_cselect_b32 s35, s20, s35
    s_cmp_eq_u32 s3, 8
    s_cbranch_scc1 k1_loader
    s_cmp_ge_u32 s3, 4
    s_cbranch_scc1 k1_kgen
    s_getpc_b64 s[62:63]
k1_pc:
    s_lshl_b32 s64, s3, 13
    v_lshl_add_u32 v126, v0, 7, s64
    v_min_u32 v126, k2_end-concat_heads__mha_block__ssm_conv_s4__prompt_kernel, v126
    s_sub_u32 s62, s62, k1_pc-concat_heads__mha_block__ssm_conv_s4__prompt_kernel
    s_subb_u32 s63, s63, 0
    global_load_dword v127, v126, s[62:63]
    v_add_u32 v126, 32768, v126
    v_min_u32 v126, k2_end-concat_heads__mha_block__ssm_conv_s4__prompt_kernel, v126
    global_load_dword v127, v126, s[62:63]
    s_barrier
    s_lshl_b32 s23, s5, 2
    s_add_u32 s23, s23, s3
    s_lshl_b32 s25, s3, 12
    s_add_u32 s25, s25, 12544
    v_and_b32 v5, 31, v0
    v_lshrrev_b32 v6, 5, v0
    v_bfe_u32 v7, v0, 1, 3
    v_xor_b32 v6, v6, v7
    v_lshlrev_b32 v5, 7, v5
    v_add_u32 v5, s25, v5
    v_xor_b32 v7, 0, v6
    v_lshl_add_u32 v8, v7, 4, v5
    v_add_u32 v116, 57344, v8
    v_add_u32 v120, 114688, v8
    v_xor_b32 v7, 2, v6
    v_lshl_add_u32 v9, v7, 4, v5
    v_add_u32 v117, 57344, v9
    v_add_u32 v121, 114688, v9
    v_xor_b32 v7, 4, v6
    v_lshl_add_u32 v10, v7, 4, v5
    v_add_u32 v118, 57344, v10
    v_add_u32 v122, 114688, v10
    v_xor_b32 v7, 6, v6
    v_lshl_add_u32 v11, v7, 4, v5
    v_add_u32 v119, 57344, v11
    v_add_u32 v123, 114688, v11
    v_bfe_u32 v5, v0, 2, 2
    v_lshrrev_b32 v6, 5, v0
    v_lshl_add_u32 v5, v6, 3, v5
    v_mul_u32_u24 v12, 192, v5
    v_and_b32 v5, 3, v0
    v_lshl_add_u32 v12, v5, 3, v12
    v_bfe_u32 v5, v0, 4, 1
    v_lshl_add_u32 v12, v5, 5, v12
    v_add_u32 v12, 256, v12
    v_add_u32 v13, 57344, v12
    v_add_u32 v124, 114688, v12
    v_mov_b32 v14, 160000
    v_mov_b32 v125, 1
    s_waitcnt lgkmcnt(0)
    s_mov_b32 s16, s60
    s_mov_b32 s17, s61
    s_mov_b32 s18, 14680064
    s_mov_b32 s19, 0x00020000
    s_mul_i32 s6, s4, 3
    s_cmp_ge_u32 s4, 10
    s_cbranch_scc1 k1_v2
    s_cmp_eq_u32 s4, 9
    s_cbranch_scc1 k1_v1
k1_v0:
    s_add_u32 s20, s6, 0
    s_cmp_ge_u32 s20, 14
    s_cselect_b32 s21, 14, 0
    s_sub_u32 s20, s20, s21
    s_cmp_ge_u32 s21, 14
    s_cselect_b32 s32, 18, 17
    s_cselect_b32 s29, 1.0, 0x3e8b97f6
    s_cselect_b32 s62, 0x3f803f80, 0
    s_cselect_b32 s63, 0x3f80, 0
    s_cselect_b32 s21, 2097152, 0
    s_sub_u32 s22, s32, 6
    s_lshl_b32 s26, s23, s22
    s_add_u32 s26, s26, s21
    s_lshl_b32 s20, s20, 2
    v_lshrrev_b32 v5, 5, v0
    v_add3_u32 v5, v5, s20, 0
    v_mul_u32_u24 v6, 37, v5
    v_lshrrev_b32 v6, 8, v6
    v_add_u32 v5, v5, v6
    v_and_b32 v6, 7, v5
    v_cmp_eq_u32 s[40:41], 3, v6
    v_lshrrev_b32 v6, 2, v5
    v_lshlrev_b32 v6, s32, v6
    v_and_b32 v5, 3, v5
    v_lshl_add_u32 v6, v5, 9, v6
    v_and_b32 v5, 31, v0
    v_lshl_add_u32 v96, v5, 4, v6
    v_lshrrev_b32 v5, 5, v0
    v_add3_u32 v5, v5, s20, 2
    v_mul_u32_u24 v6, 37, v5
    v_lshrrev_b32 v6, 8, v6
    v_add_u32 v5, v5, v6
    v_and_b32 v6, 7, v5
    v_cmp_eq_u32 s[42:43], 3, v6
    v_lshrrev_b32 v6, 2, v5
    v_lshlrev_b32 v6, s32, v6
    v_and_b32 v5, 3, v5
    v_lshl_add_u32 v6, v5, 9, v6
    v_and_b32 v5, 31, v0
    v_lshl_add_u32 v97, v5, 4, v6
    s_add_u32 s20, s6, 1
    s_cmp_ge_u32 s20, 14
    s_cselect_b32 s21, 14, 0
    s_sub_u32 s20, s20, s21
    s_cmp_ge_u32 s21, 14
    s_cselect_b32 s33, 18, 17
    s_cselect_b32 s30, 1.0, 0x3e8b97f6
    s_cselect_b32 s64, 0x3f803f80, 0
    s_cselect_b32 s65, 0x3f80, 0
    s_cselect_b32 s21, 2097152, 0
    s_sub_u32 s22, s33, 6
    s_lshl_b32 s27, s23, s22
    s_add_u32 s27, s27, s21
    s_lshl_b32 s20, s20, 2
    v_lshrrev_b32 v5, 5, v0
    v_add3_u32 v5, v5, s20, 0
    v_mul_u32_u24 v6, 37, v5
    v_lshrrev_b32 v6, 8, v6
    v_add_u32 v5, v5, v6
    v_and_b32 v6, 7, v5
    v_cmp_eq_u32 s[44:45], 3, v6
    v_lshrrev_b32 v6, 2, v5
    v_lshlrev_b32 v6, s33, v6
    v_and_b32 v5, 3, v5
    v_lshl_add_u32 v6, v5, 9, v6
    v_and_b32 v5, 31, v0
    v_lshl_add_u32 v98, v5, 4, v6
    v_lshrrev_b32 v5, 5, v0
    v_add3_u32 v5, v5, s20, 2
    v_mul_u32_u24 v6, 37, v5
    v_lshrrev_b32 v6, 8, v6
    v_add_u32 v5, v5, v6
    v_and_b32 v6, 7, v5
    v_cmp_eq_u32 s[46:47], 3, v6
    v_lshrrev_b32 v6, 2, v5
    v_lshlrev_b32 v6, s33, v6
    v_and_b32 v5, 3, v5
    v_lshl_add_u32 v6, v5, 9, v6
    v_and_b32 v5, 31, v0
    v_lshl_add_u32 v99, v5, 4, v6
    s_add_u32 s20, s6, 2
    s_cmp_ge_u32 s20, 14
    s_cselect_b32 s21, 14, 0
    s_sub_u32 s20, s20, s21
    s_cmp_ge_u32 s21, 14
    s_cselect_b32 s34, 18, 17
    s_cselect_b32 s31, 1.0, 0x3e8b97f6
    s_cselect_b32 s66, 0x3f803f80, 0
    s_cselect_b32 s67, 0x3f80, 0
    s_cselect_b32 s21, 2097152, 0
    s_sub_u32 s22, s34, 6
    s_lshl_b32 s28, s23, s22
    s_add_u32 s28, s28, s21
    s_lshl_b32 s20, s20, 2
    v_lshrrev_b32 v5, 5, v0
    v_add3_u32 v5, v5, s20, 0
    v_mul_u32_u24 v6, 37, v5
    v_lshrrev_b32 v6, 8, v6
    v_add_u32 v5, v5, v6
    v_and_b32 v6, 7, v5
    v_cmp_eq_u32 s[48:49], 3, v6
    v_lshrrev_b32 v6, 2, v5
    v_lshlrev_b32 v6, s34, v6
    v_and_b32 v5, 3, v5
    v_lshl_add_u32 v6, v5, 9, v6
    v_and_b32 v5, 31, v0
    v_lshl_add_u32 v100, v5, 4, v6
    v_lshrrev_b32 v5, 5, v0
    v_add3_u32 v5, v5, s20, 2
    v_mul_u32_u24 v6, 37, v5
    v_lshrrev_b32 v6, 8, v6
    v_add_u32 v5, v5, v6
    v_and_b32 v6, 7, v5
    v_cmp_eq_u32 s[50:51], 3, v6
    v_lshrrev_b32 v6, 2, v5
    v_lshlrev_b32 v6, s34, v6
    v_and_b32 v5, 3, v5
    v_lshl_add_u32 v6, v5, 9, v6
    v_and_b32 v5, 31, v0
    v_lshl_add_u32 v101, v5, 4, v6
k1_kernel_poll_1:
    ds_read_b32 v5, v14 offset:0
    s_waitcnt lgkmcnt(0)
    v_readfirstlane_b32 s20, v5
    s_cmp_lt_u32 s20, 1
    s_cbranch_scc1 k1_kernel_poll_1
    ds_read_b128 v[64:67], v8 offset:0
    ds_read_b64_tr_b16 v[68:69], v12 offset:0
    ds_read_b64_tr_b16 v[70:71], v12 offset:768
    ds_read_b64_tr_b16 v[72:73], v12 offset:64
    ds_read_b64_tr_b16 v[74:75], v12 offset:832
    ds_read_b64_tr_b16 v[76:77], v12 offset:128
    ds_read_b64_tr_b16 v[78:79], v12 offset:896
    ds_read_b128 v[80:83], v9 offset:0
    ds_read_b64_tr_b16 v[84:85], v12 offset:3072
    ds_read_b64_tr_b16 v[86:87], v12 offset:3840
    ds_read_b64_tr_b16 v[88:89], v12 offset:3136
    ds_read_b64_tr_b16 v[90:91], v12 offset:3904
    ds_read_b64_tr_b16 v[92:93], v12 offset:3200
    ds_read_b64_tr_b16 v[94:95], v12 offset:3968
    ds_read_b32 v15, v14 offset:4
    ds_read_b128 v[128:131], v10 offset:0
    ds_read_b64_tr_b16 v[132:133], v12 offset:6144
    ds_read_b64_tr_b16 v[134:135], v12 offset:6912
    ds_read_b64_tr_b16 v[136:137], v12 offset:6208
    ds_read_b64_tr_b16 v[138:139], v12 offset:6976
    ds_read_b64_tr_b16 v[140:141], v12 offset:6272
    ds_read_b64_tr_b16 v[142:143], v12 offset:7040
    s_waitcnt lgkmcnt(15)
    v_mfma_f32_32x32x16_bf16 v[16:31], v[68:71], v[64:67], 0
    v_mfma_f32_32x32x16_bf16 v[32:47], v[72:75], v[64:67], 0
    v_mfma_f32_32x32x16_bf16 v[48:63], v[76:79], v[64:67], 0
    ds_read_b128 v[64:67], v11 offset:0
    ds_read_b64_tr_b16 v[68:69], v12 offset:9216
    ds_read_b64_tr_b16 v[70:71], v12 offset:9984
    ds_read_b64_tr_b16 v[72:73], v12 offset:9280
    ds_read_b64_tr_b16 v[74:75], v12 offset:10048
    ds_read_b64_tr_b16 v[76:77], v12 offset:9344
    ds_read_b64_tr_b16 v[78:79], v12 offset:10112
    s_waitcnt lgkmcnt(15)
    v_mfma_f32_32x32x16_bf16 v[16:31], v[84:87], v[80:83], v[16:31]
    v_mfma_f32_32x32x16_bf16 v[32:47], v[88:91], v[80:83], v[32:47]
    v_mfma_f32_32x32x16_bf16 v[48:63], v[92:95], v[80:83], v[48:63]
    s_waitcnt lgkmcnt(14)
    v_readfirstlane_b32 s35, v15
    s_cmp_ge_u32 s35, 1
    s_cbranch_scc1 k1_kernel_ok_2
k1_kernel_poll_3:
    ds_read_b32 v5, v14 offset:4
    s_waitcnt lgkmcnt(0)
    v_readfirstlane_b32 s20, v5
    s_cmp_lt_u32 s20, 1
    s_cbranch_scc1 k1_kernel_poll_3
k1_kernel_ok_2:
    ds_read_b128 v[80:83], v8 offset:28672
    ds_read_b64_tr_b16 v[84:85], v12 offset:28672
    ds_read_b64_tr_b16 v[86:87], v12 offset:29440
    ds_read_b64_tr_b16 v[88:89], v12 offset:28736
    ds_read_b64_tr_b16 v[90:91], v12 offset:29504
    ds_read_b64_tr_b16 v[92:93], v12 offset:28800
    ds_read_b64_tr_b16 v[94:95], v12 offset:29568
    s_waitcnt lgkmcnt(14)
    v_mfma_f32_32x32x16_bf16 v[16:31], v[132:135], v[128:131], v[16:31]
    v_mfma_f32_32x32x16_bf16 v[32:47], v[136:139], v[128:131], v[32:47]
    v_mfma_f32_32x32x16_bf16 v[48:63], v[140:143], v[128:131], v[48:63]
    ds_read_b128 v[128:131], v9 offset:28672
    ds_read_b64_tr_b16 v[132:133], v12 offset:31744
    ds_read_b64_tr_b16 v[134:135], v12 offset:32512
    ds_read_b64_tr_b16 v[136:137], v12 offset:31808
    ds_read_b64_tr_b16 v[138:139], v12 offset:32576
    ds_read_b64_tr_b16 v[140:141], v12 offset:31872
    ds_read_b64_tr_b16 v[142:143], v12 offset:32640
    s_waitcnt lgkmcnt(14)
    v_mfma_f32_32x32x16_bf16 v[16:31], v[68:71], v[64:67], v[16:31]
    v_mfma_f32_32x32x16_bf16 v[32:47], v[72:75], v[64:67], v[32:47]
    v_mfma_f32_32x32x16_bf16 v[48:63], v[76:79], v[64:67], v[48:63]
    s_mov_b64 exec, 1
    ds_add_u32 v14, v125 offset:40
    s_mov_b64 exec, -1
    ds_read_b32 v15, v14 offset:8
    ds_read_b128 v[64:67], v10 offset:28672
    ds_read_b64_tr_b16 v[68:69], v12 offset:34816
    ds_read_b64_tr_b16 v[70:71], v12 offset:35584
    ds_read_b64_tr_b16 v[72:73], v12 offset:34880
    ds_read_b64_tr_b16 v[74:75], v12 offset:35648
    ds_read_b64_tr_b16 v[76:77], v12 offset:34944
    ds_read_b64_tr_b16 v[78:79], v12 offset:35712
    s_waitcnt lgkmcnt(15)
    v_mfma_f32_32x32x16_bf16 v[16:31], v[84:87], v[80:83], v[16:31]
    v_mfma_f32_32x32x16_bf16 v[32:47], v[88:91], v[80:83], v[32:47]
    v_mfma_f32_32x32x16_bf16 v[48:63], v[92:95], v[80:83], v[48:63]
    ds_read_b128 v[80:83], v11 offset:28672
    ds_read_b64_tr_b16 v[84:85], v12 offset:37888
    ds_read_b64_tr_b16 v[86:87], v12 offset:38656
    ds_read_b64_tr_b16 v[88:89], v12 offset:37952
    ds_read_b64_tr_b16 v[90:91], v12 offset:38720
    ds_read_b64_tr_b16 v[92:93], v12 offset:38016
    ds_read_b64_tr_b16 v[94:95], v12 offset:38784
    s_waitcnt lgkmcnt(15)
    v_mfma_f32_32x32x16_bf16 v[16:31], v[132:135], v[128:131], v[16:31]
    v_mfma_f32_32x32x16_bf16 v[32:47], v[136:139], v[128:131], v[32:47]
    v_mfma_f32_32x32x16_bf16 v[48:63], v[140:143], v[128:131], v[48:63]
    s_waitcnt lgkmcnt(14)
    v_readfirstlane_b32 s35, v15
    s_cmp_ge_u32 s35, 1
    s_cbranch_scc1 k1_kernel_ok_4
k1_kernel_poll_5:
    ds_read_b32 v5, v14 offset:8
    s_waitcnt lgkmcnt(0)
    v_readfirstlane_b32 s20, v5
    s_cmp_lt_u32 s20, 1
    s_cbranch_scc1 k1_kernel_poll_5
k1_kernel_ok_4:
    ds_read_b128 v[128:131], v116 offset:0
    ds_read_b64_tr_b16 v[132:133], v13 offset:0
    ds_read_b64_tr_b16 v[134:135], v13 offset:768
    ds_read_b64_tr_b16 v[136:137], v13 offset:64
    ds_read_b64_tr_b16 v[138:139], v13 offset:832
    ds_read_b64_tr_b16 v[140:141], v13 offset:128
    ds_read_b64_tr_b16 v[142:143], v13 offset:896
    s_waitcnt lgkmcnt(14)
    v_mfma_f32_32x32x16_bf16 v[16:31], v[68:71], v[64:67], v[16:31]
    v_mfma_f32_32x32x16_bf16 v[32:47], v[72:75], v[64:67], v[32:47]
    v_mfma_f32_32x32x16_bf16 v[48:63], v[76:79], v[64:67], v[48:63]
    ds_read_b128 v[64:67], v117 offset:0
    ds_read_b64_tr_b16 v[68:69], v13 offset:3072
    ds_read_b64_tr_b16 v[70:71], v13 offset:3840
    ds_read_b64_tr_b16 v[72:73], v13 offset:3136
    ds_read_b64_tr_b16 v[74:75], v13 offset:3904
    ds_read_b64_tr_b16 v[76:77], v13 offset:3200
    ds_read_b64_tr_b16 v[78:79], v13 offset:3968
    s_waitcnt lgkmcnt(14)
    v_mfma_f32_32x32x16_bf16 v[16:31], v[84:87], v[80:83], v[16:31]
    v_mfma_f32_32x32x16_bf16 v[32:47], v[88:91], v[80:83], v[32:47]
    v_mfma_f32_32x32x16_bf16 v[48:63], v[92:95], v[80:83], v[48:63]
    s_mov_b64 exec, 1
    ds_add_u32 v14, v125 offset:44
    s_mov_b64 exec, -1
    ds_read_b32 v15, v14 offset:12
    ds_read_b128 v[80:83], v118 offset:0
    ds_read_b64_tr_b16 v[84:85], v13 offset:6144
    ds_read_b64_tr_b16 v[86:87], v13 offset:6912
    ds_read_b64_tr_b16 v[88:89], v13 offset:6208
    ds_read_b64_tr_b16 v[90:91], v13 offset:6976
    ds_read_b64_tr_b16 v[92:93], v13 offset:6272
    ds_read_b64_tr_b16 v[94:95], v13 offset:7040
    s_waitcnt lgkmcnt(15)
    v_mfma_f32_32x32x16_bf16 v[16:31], v[132:135], v[128:131], v[16:31]
    v_mfma_f32_32x32x16_bf16 v[32:47], v[136:139], v[128:131], v[32:47]
    v_mfma_f32_32x32x16_bf16 v[48:63], v[140:143], v[128:131], v[48:63]
    ds_read_b128 v[128:131], v119 offset:0
    ds_read_b64_tr_b16 v[132:133], v13 offset:9216
    ds_read_b64_tr_b16 v[134:135], v13 offset:9984
    ds_read_b64_tr_b16 v[136:137], v13 offset:9280
    ds_read_b64_tr_b16 v[138:139], v13 offset:10048
    ds_read_b64_tr_b16 v[140:141], v13 offset:9344
    ds_read_b64_tr_b16 v[142:143], v13 offset:10112
    s_waitcnt lgkmcnt(15)
    v_mfma_f32_32x32x16_bf16 v[16:31], v[68:71], v[64:67], v[16:31]
    v_mfma_f32_32x32x16_bf16 v[32:47], v[72:75], v[64:67], v[32:47]
    v_mfma_f32_32x32x16_bf16 v[48:63], v[76:79], v[64:67], v[48:63]
    s_waitcnt lgkmcnt(14)
    v_readfirstlane_b32 s35, v15
    s_cmp_ge_u32 s35, 1
    s_cbranch_scc1 k1_kernel_ok_6
k1_kernel_poll_7:
    ds_read_b32 v5, v14 offset:12
    s_waitcnt lgkmcnt(0)
    v_readfirstlane_b32 s20, v5
    s_cmp_lt_u32 s20, 1
    s_cbranch_scc1 k1_kernel_poll_7
k1_kernel_ok_6:
    ds_read_b128 v[64:67], v116 offset:28672
    ds_read_b64_tr_b16 v[68:69], v13 offset:28672
    ds_read_b64_tr_b16 v[70:71], v13 offset:29440
    ds_read_b64_tr_b16 v[72:73], v13 offset:28736
    ds_read_b64_tr_b16 v[74:75], v13 offset:29504
    ds_read_b64_tr_b16 v[76:77], v13 offset:28800
    ds_read_b64_tr_b16 v[78:79], v13 offset:29568
    s_waitcnt lgkmcnt(14)
    v_mfma_f32_32x32x16_bf16 v[16:31], v[84:87], v[80:83], v[16:31]
    v_mfma_f32_32x32x16_bf16 v[32:47], v[88:91], v[80:83], v[32:47]
    v_mfma_f32_32x32x16_bf16 v[48:63], v[92:95], v[80:83], v[48:63]
    ds_read_b128 v[80:83], v117 offset:28672
    ds_read_b64_tr_b16 v[84:85], v13 offset:31744
    ds_read_b64_tr_b16 v[86:87], v13 offset:32512
    ds_read_b64_tr_b16 v[88:89], v13 offset:31808
    ds_read_b64_tr_b16 v[90:91], v13 offset:32576
    ds_read_b64_tr_b16 v[92:93], v13 offset:31872
    ds_read_b64_tr_b16 v[94:95], v13 offset:32640
    s_waitcnt lgkmcnt(14)
    v_mfma_f32_32x32x16_bf16 v[16:31], v[132:135], v[128:131], v[16:31]
    v_mfma_f32_32x32x16_bf16 v[32:47], v[136:139], v[128:131], v[32:47]
    v_mfma_f32_32x32x16_bf16 v[48:63], v[140:143], v[128:131], v[48:63]
    s_mov_b64 exec, 1
    ds_add_u32 v14, v125 offset:48
    s_mov_b64 exec, -1
    ds_read_b32 v15, v14 offset:16
    ds_read_b128 v[128:131], v118 offset:28672
    ds_read_b64_tr_b16 v[132:133], v13 offset:34816
    ds_read_b64_tr_b16 v[134:135], v13 offset:35584
    ds_read_b64_tr_b16 v[136:137], v13 offset:34880
    ds_read_b64_tr_b16 v[138:139], v13 offset:35648
    ds_read_b64_tr_b16 v[140:141], v13 offset:34944
    ds_read_b64_tr_b16 v[142:143], v13 offset:35712
    s_waitcnt lgkmcnt(15)
    v_mfma_f32_32x32x16_bf16 v[16:31], v[68:71], v[64:67], v[16:31]
    v_mfma_f32_32x32x16_bf16 v[32:47], v[72:75], v[64:67], v[32:47]
    v_mfma_f32_32x32x16_bf16 v[48:63], v[76:79], v[64:67], v[48:63]
    ds_read_b128 v[64:67], v119 offset:28672
    ds_read_b64_tr_b16 v[68:69], v13 offset:37888
    ds_read_b64_tr_b16 v[70:71], v13 offset:38656
    ds_read_b64_tr_b16 v[72:73], v13 offset:37952
    ds_read_b64_tr_b16 v[74:75], v13 offset:38720
    ds_read_b64_tr_b16 v[76:77], v13 offset:38016
    ds_read_b64_tr_b16 v[78:79], v13 offset:38784
    s_waitcnt lgkmcnt(15)
    v_mfma_f32_32x32x16_bf16 v[16:31], v[84:87], v[80:83], v[16:31]
    v_mfma_f32_32x32x16_bf16 v[32:47], v[88:91], v[80:83], v[32:47]
    v_mfma_f32_32x32x16_bf16 v[48:63], v[92:95], v[80:83], v[48:63]
    s_waitcnt lgkmcnt(14)
    v_readfirstlane_b32 s35, v15
    s_cmp_ge_u32 s35, 1
    s_cbranch_scc1 k1_kernel_ok_8
k1_kernel_poll_9:
    ds_read_b32 v5, v14 offset:16
    s_waitcnt lgkmcnt(0)
    v_readfirstlane_b32 s20, v5
    s_cmp_lt_u32 s20, 1
    s_cbranch_scc1 k1_kernel_poll_9
k1_kernel_ok_8:
    ds_read_b128 v[80:83], v120 offset:0
    ds_read_b64_tr_b16 v[84:85], v124 offset:0
    ds_read_b64_tr_b16 v[86:87], v124 offset:768
    ds_read_b64_tr_b16 v[88:89], v124 offset:64
    ds_read_b64_tr_b16 v[90:91], v124 offset:832
    ds_read_b64_tr_b16 v[92:93], v124 offset:128
    ds_read_b64_tr_b16 v[94:95], v124 offset:896
    s_waitcnt lgkmcnt(14)
    v_mfma_f32_32x32x16_bf16 v[16:31], v[132:135], v[128:131], v[16:31]
    v_mfma_f32_32x32x16_bf16 v[32:47], v[136:139], v[128:131], v[32:47]
    v_mfma_f32_32x32x16_bf16 v[48:63], v[140:143], v[128:131], v[48:63]
    ds_read_b128 v[128:131], v121 offset:0
    ds_read_b64_tr_b16 v[132:133], v124 offset:3072
    ds_read_b64_tr_b16 v[134:135], v124 offset:3840
    ds_read_b64_tr_b16 v[136:137], v124 offset:3136
    ds_read_b64_tr_b16 v[138:139], v124 offset:3904
    ds_read_b64_tr_b16 v[140:141], v124 offset:3200
    ds_read_b64_tr_b16 v[142:143], v124 offset:3968
    s_waitcnt lgkmcnt(14)
    v_mfma_f32_32x32x16_bf16 v[16:31], v[68:71], v[64:67], v[16:31]
    v_mfma_f32_32x32x16_bf16 v[32:47], v[72:75], v[64:67], v[32:47]
    v_mfma_f32_32x32x16_bf16 v[48:63], v[76:79], v[64:67], v[48:63]
    ds_read_b32 v15, v14 offset:20
    ds_read_b128 v[64:67], v122 offset:0
    ds_read_b64_tr_b16 v[68:69], v124 offset:6144
    ds_read_b64_tr_b16 v[70:71], v124 offset:6912
    ds_read_b64_tr_b16 v[72:73], v124 offset:6208
    ds_read_b64_tr_b16 v[74:75], v124 offset:6976
    ds_read_b64_tr_b16 v[76:77], v124 offset:6272
    ds_read_b64_tr_b16 v[78:79], v124 offset:7040
    s_waitcnt lgkmcnt(15)
    v_mfma_f32_32x32x16_bf16 v[16:31], v[84:87], v[80:83], v[16:31]
    v_mfma_f32_32x32x16_bf16 v[32:47], v[88:91], v[80:83], v[32:47]
    v_mfma_f32_32x32x16_bf16 v[48:63], v[92:95], v[80:83], v[48:63]
    ds_read_b128 v[80:83], v123 offset:0
    ds_read_b64_tr_b16 v[84:85], v124 offset:9216
    ds_read_b64_tr_b16 v[86:87], v124 offset:9984
    ds_read_b64_tr_b16 v[88:89], v124 offset:9280
    ds_read_b64_tr_b16 v[90:91], v124 offset:10048
    ds_read_b64_tr_b16 v[92:93], v124 offset:9344
    ds_read_b64_tr_b16 v[94:95], v124 offset:10112
    s_waitcnt lgkmcnt(15)
    v_mfma_f32_32x32x16_bf16 v[16:31], v[132:135], v[128:131], v[16:31]
    v_mfma_f32_32x32x16_bf16 v[32:47], v[136:139], v[128:131], v[32:47]
    v_mfma_f32_32x32x16_bf16 v[48:63], v[140:143], v[128:131], v[48:63]
    s_waitcnt lgkmcnt(14)
    v_readfirstlane_b32 s35, v15
    s_cmp_ge_u32 s35, 1
    s_cbranch_scc1 k1_kernel_ok_10
k1_kernel_poll_11:
    ds_read_b32 v5, v14 offset:20
    s_waitcnt lgkmcnt(0)
    v_readfirstlane_b32 s20, v5
    s_cmp_lt_u32 s20, 1
    s_cbranch_scc1 k1_kernel_poll_11
k1_kernel_ok_10:
    ds_read_b128 v[128:131], v8 offset:0
    ds_read_b64_tr_b16 v[132:133], v12 offset:0
    ds_read_b64_tr_b16 v[134:135], v12 offset:768
    ds_read_b64_tr_b16 v[136:137], v12 offset:64
    ds_read_b64_tr_b16 v[138:139], v12 offset:832
    ds_read_b64_tr_b16 v[140:141], v12 offset:128
    ds_read_b64_tr_b16 v[142:143], v12 offset:896
    s_waitcnt lgkmcnt(14)
    v_mfma_f32_32x32x16_bf16 v[16:31], v[68:71], v[64:67], v[16:31]
    v_mfma_f32_32x32x16_bf16 v[32:47], v[72:75], v[64:67], v[32:47]
    v_mfma_f32_32x32x16_bf16 v[48:63], v[76:79], v[64:67], v[48:63]
    ds_read_b128 v[64:67], v9 offset:0
    ds_read_b64_tr_b16 v[68:69], v12 offset:3072
    ds_read_b64_tr_b16 v[70:71], v12 offset:3840
    ds_read_b64_tr_b16 v[72:73], v12 offset:3136
    ds_read_b64_tr_b16 v[74:75], v12 offset:3904
    ds_read_b64_tr_b16 v[76:77], v12 offset:3200
    ds_read_b64_tr_b16 v[78:79], v12 offset:3968
    s_waitcnt lgkmcnt(14)
    v_mfma_f32_32x32x16_bf16 v[16:31], v[84:87], v[80:83], v[16:31]
    v_mfma_f32_32x32x16_bf16 v[32:47], v[88:91], v[80:83], v[32:47]
    v_mfma_f32_32x32x16_bf16 v[48:63], v[92:95], v[80:83], v[48:63]
    ds_read_b32 v15, v14 offset:24
    ds_read_b128 v[80:83], v10 offset:0
    ds_read_b64_tr_b16 v[84:85], v12 offset:6144
    ds_read_b64_tr_b16 v[86:87], v12 offset:6912
    ds_read_b64_tr_b16 v[88:89], v12 offset:6208
    ds_read_b64_tr_b16 v[90:91], v12 offset:6976
    ds_read_b64_tr_b16 v[92:93], v12 offset:6272
    ds_read_b64_tr_b16 v[94:95], v12 offset:7040
    s_waitcnt lgkmcnt(15)
    v_mfma_f32_32x32x16_bf16 v[16:31], v[132:135], v[128:131], v[16:31]
    v_mfma_f32_32x32x16_bf16 v[32:47], v[136:139], v[128:131], v[32:47]
    v_mfma_f32_32x32x16_bf16 v[48:63], v[140:143], v[128:131], v[48:63]
    ds_read_b128 v[128:131], v11 offset:0
    ds_read_b64_tr_b16 v[132:133], v12 offset:9216
    ds_read_b64_tr_b16 v[134:135], v12 offset:9984
    ds_read_b64_tr_b16 v[136:137], v12 offset:9280
    ds_read_b64_tr_b16 v[138:139], v12 offset:10048
    ds_read_b64_tr_b16 v[140:141], v12 offset:9344
    ds_read_b64_tr_b16 v[142:143], v12 offset:10112
    s_waitcnt lgkmcnt(15)
    v_mfma_f32_32x32x16_bf16 v[16:31], v[68:71], v[64:67], v[16:31]
    v_mfma_f32_32x32x16_bf16 v[32:47], v[72:75], v[64:67], v[32:47]
    v_mfma_f32_32x32x16_bf16 v[48:63], v[76:79], v[64:67], v[48:63]
    s_waitcnt lgkmcnt(14)
    v_readfirstlane_b32 s35, v15
    s_cmp_ge_u32 s35, 1
    s_cbranch_scc1 k1_kernel_ok_12
k1_kernel_poll_13:
    ds_read_b32 v5, v14 offset:24
    s_waitcnt lgkmcnt(0)
    v_readfirstlane_b32 s20, v5
    s_cmp_lt_u32 s20, 1
    s_cbranch_scc1 k1_kernel_poll_13
k1_kernel_ok_12:
    ds_read_b128 v[64:67], v8 offset:28672
    ds_read_b64_tr_b16 v[68:69], v12 offset:28672
    ds_read_b64_tr_b16 v[70:71], v12 offset:29440
    ds_read_b64_tr_b16 v[72:73], v12 offset:28736
    ds_read_b64_tr_b16 v[74:75], v12 offset:29504
    ds_read_b64_tr_b16 v[76:77], v12 offset:28800
    ds_read_b64_tr_b16 v[78:79], v12 offset:29568
    s_waitcnt lgkmcnt(14)
    v_mfma_f32_32x32x16_bf16 v[16:31], v[84:87], v[80:83], v[16:31]
    v_mfma_f32_32x32x16_bf16 v[32:47], v[88:91], v[80:83], v[32:47]
    v_mfma_f32_32x32x16_bf16 v[48:63], v[92:95], v[80:83], v[48:63]
    ds_read_b128 v[80:83], v9 offset:28672
    ds_read_b64_tr_b16 v[84:85], v12 offset:31744
    ds_read_b64_tr_b16 v[86:87], v12 offset:32512
    ds_read_b64_tr_b16 v[88:89], v12 offset:31808
    ds_read_b64_tr_b16 v[90:91], v12 offset:32576
    ds_read_b64_tr_b16 v[92:93], v12 offset:31872
    ds_read_b64_tr_b16 v[94:95], v12 offset:32640
    s_waitcnt lgkmcnt(14)
    v_mfma_f32_32x32x16_bf16 v[16:31], v[132:135], v[128:131], v[16:31]
    v_mfma_f32_32x32x16_bf16 v[32:47], v[136:139], v[128:131], v[32:47]
    v_mfma_f32_32x32x16_bf16 v[48:63], v[140:143], v[128:131], v[48:63]
    ds_read_b128 v[128:131], v10 offset:28672
    ds_read_b64_tr_b16 v[132:133], v12 offset:34816
    ds_read_b64_tr_b16 v[134:135], v12 offset:35584
    ds_read_b64_tr_b16 v[136:137], v12 offset:34880
    ds_read_b64_tr_b16 v[138:139], v12 offset:35648
    ds_read_b64_tr_b16 v[140:141], v12 offset:34944
    ds_read_b64_tr_b16 v[142:143], v12 offset:35712
    s_waitcnt lgkmcnt(14)
    v_mfma_f32_32x32x16_bf16 v[16:31], v[68:71], v[64:67], v[16:31]
    v_mfma_f32_32x32x16_bf16 v[32:47], v[72:75], v[64:67], v[32:47]
    v_mfma_f32_32x32x16_bf16 v[48:63], v[76:79], v[64:67], v[48:63]
    ds_read_b128 v[64:67], v11 offset:28672
    ds_read_b64_tr_b16 v[68:69], v12 offset:37888
    ds_read_b64_tr_b16 v[70:71], v12 offset:38656
    ds_read_b64_tr_b16 v[72:73], v12 offset:37952
    ds_read_b64_tr_b16 v[74:75], v12 offset:38720
    ds_read_b64_tr_b16 v[76:77], v12 offset:38016
    ds_read_b64_tr_b16 v[78:79], v12 offset:38784
    s_waitcnt lgkmcnt(14)
    v_mfma_f32_32x32x16_bf16 v[16:31], v[84:87], v[80:83], v[16:31]
    v_mfma_f32_32x32x16_bf16 v[32:47], v[88:91], v[80:83], v[32:47]
    v_mfma_f32_32x32x16_bf16 v[48:63], v[92:95], v[80:83], v[48:63]
    s_waitcnt lgkmcnt(7)
    v_mfma_f32_32x32x16_bf16 v[16:31], v[132:135], v[128:131], v[16:31]
    v_mfma_f32_32x32x16_bf16 v[32:47], v[136:139], v[128:131], v[32:47]
    v_mfma_f32_32x32x16_bf16 v[48:63], v[140:143], v[128:131], v[48:63]
    s_waitcnt lgkmcnt(0)
    v_mfma_f32_32x32x16_bf16 v[16:31], v[68:71], v[64:67], v[16:31]
    v_mfma_f32_32x32x16_bf16 v[32:47], v[72:75], v[64:67], v[32:47]
    v_mfma_f32_32x32x16_bf16 v[48:63], v[76:79], v[64:67], v[48:63]
    s_nop 9
    v_pk_mul_f32 v[16:17], v[16:17], s[28:29] op_sel:[0,1] op_sel_hi:[1,1]
    v_pk_mul_f32 v[18:19], v[18:19], s[28:29] op_sel:[0,1] op_sel_hi:[1,1]
    v_pk_mul_f32 v[20:21], v[20:21], s[28:29] op_sel:[0,1] op_sel_hi:[1,1]
    v_pk_mul_f32 v[22:23], v[22:23], s[28:29] op_sel:[0,1] op_sel_hi:[1,1]
    v_pk_mul_f32 v[24:25], v[24:25], s[28:29] op_sel:[0,1] op_sel_hi:[1,1]
    v_pk_mul_f32 v[26:27], v[26:27], s[28:29] op_sel:[0,1] op_sel_hi:[1,1]
    v_pk_mul_f32 v[28:29], v[28:29], s[28:29] op_sel:[0,1] op_sel_hi:[1,1]
    v_pk_mul_f32 v[30:31], v[30:31], s[28:29] op_sel:[0,1] op_sel_hi:[1,1]
    v_cvt_pk_bf16_f32 v64, v16, v17
    v_cvt_pk_bf16_f32 v65, v18, v19
    v_cvt_pk_bf16_f32 v66, v20, v21
    v_cvt_pk_bf16_f32 v67, v22, v23
    v_cvt_pk_bf16_f32 v68, v24, v25
    v_cvt_pk_bf16_f32 v69, v26, v27
    v_cvt_pk_bf16_f32 v70, v28, v29
    v_cvt_pk_bf16_f32 v71, v30, v31
    v_permlane32_swap_b32 v64, v66
    v_permlane32_swap_b32 v65, v67
    v_permlane32_swap_b32 v68, v70
    v_permlane32_swap_b32 v69, v71
    v_mov_b32 v74, s62
    v_mov_b32 v75, s63
    s_lshl_b32 s21, 1, s32
    s_add_u32 s21, s21, s26
    s_mov_b64 exec, s[40:41]
    s_cbranch_execz k1_kernel_nomix_14
    v_mov_b32 v72, v66
    v_mov_b32 v73, v67
    v_mov_b32 v66, v74
    v_mov_b32 v67, v75
    buffer_store_dwordx4 v[72:75], v96, s[16:19], s21 offen sc0 sc1
k1_kernel_nomix_14:
    s_mov_b64 exec, -1
    buffer_store_dwordx4 v[64:67], v96, s[16:19], s26 offen sc0 sc1
    s_mov_b64 exec, s[42:43]
    s_cbranch_execz k1_kernel_nomix_15
    v_mov_b32 v72, v70
    v_mov_b32 v73, v71
    v_mov_b32 v70, v74
    v_mov_b32 v71, v75
    buffer_store_dwordx4 v[72:75], v97, s[16:19], s21 offen sc0 sc1
k1_kernel_nomix_15:
    s_mov_b64 exec, -1
    buffer_store_dwordx4 v[68:71], v97, s[16:19], s26 offen sc0 sc1
    v_pk_mul_f32 v[32:33], v[32:33], s[30:31] op_sel_hi:[1,0]
    v_pk_mul_f32 v[34:35], v[34:35], s[30:31] op_sel_hi:[1,0]
    v_pk_mul_f32 v[36:37], v[36:37], s[30:31] op_sel_hi:[1,0]
    v_pk_mul_f32 v[38:39], v[38:39], s[30:31] op_sel_hi:[1,0]
    v_pk_mul_f32 v[40:41], v[40:41], s[30:31] op_sel_hi:[1,0]
    v_pk_mul_f32 v[42:43], v[42:43], s[30:31] op_sel_hi:[1,0]
    v_pk_mul_f32 v[44:45], v[44:45], s[30:31] op_sel_hi:[1,0]
    v_pk_mul_f32 v[46:47], v[46:47], s[30:31] op_sel_hi:[1,0]
    v_cvt_pk_bf16_f32 v76, v32, v33
    v_cvt_pk_bf16_f32 v77, v34, v35
    v_cvt_pk_bf16_f32 v78, v36, v37
    v_cvt_pk_bf16_f32 v79, v38, v39
    v_cvt_pk_bf16_f32 v80, v40, v41
    v_cvt_pk_bf16_f32 v81, v42, v43
    v_cvt_pk_bf16_f32 v82, v44, v45
    v_cvt_pk_bf16_f32 v83, v46, v47
    v_permlane32_swap_b32 v76, v78
    v_permlane32_swap_b32 v77, v79
    v_permlane32_swap_b32 v80, v82
    v_permlane32_swap_b32 v81, v83
    v_mov_b32 v86, s64
    v_mov_b32 v87, s65
    s_lshl_b32 s21, 1, s33
    s_add_u32 s21, s21, s27
    s_mov_b64 exec, s[44:45]
    s_cbranch_execz k1_kernel_nomix_16
    v_mov_b32 v84, v78
    v_mov_b32 v85, v79
    v_mov_b32 v78, v86
    v_mov_b32 v79, v87
    buffer_store_dwordx4 v[84:87], v98, s[16:19], s21 offen sc0 sc1
k1_kernel_nomix_16:
    s_mov_b64 exec, -1
    buffer_store_dwordx4 v[76:79], v98, s[16:19], s27 offen sc0 sc1
    s_mov_b64 exec, s[46:47]
    s_cbranch_execz k1_kernel_nomix_17
    v_mov_b32 v84, v82
    v_mov_b32 v85, v83
    v_mov_b32 v82, v86
    v_mov_b32 v83, v87
    buffer_store_dwordx4 v[84:87], v99, s[16:19], s21 offen sc0 sc1
k1_kernel_nomix_17:
    s_mov_b64 exec, -1
    buffer_store_dwordx4 v[80:83], v99, s[16:19], s27 offen sc0 sc1
    v_pk_mul_f32 v[48:49], v[48:49], s[30:31] op_sel:[0,1] op_sel_hi:[1,1]
    v_pk_mul_f32 v[50:51], v[50:51], s[30:31] op_sel:[0,1] op_sel_hi:[1,1]
    v_pk_mul_f32 v[52:53], v[52:53], s[30:31] op_sel:[0,1] op_sel_hi:[1,1]
    v_pk_mul_f32 v[54:55], v[54:55], s[30:31] op_sel:[0,1] op_sel_hi:[1,1]
    v_pk_mul_f32 v[56:57], v[56:57], s[30:31] op_sel:[0,1] op_sel_hi:[1,1]
    v_pk_mul_f32 v[58:59], v[58:59], s[30:31] op_sel:[0,1] op_sel_hi:[1,1]
    v_pk_mul_f32 v[60:61], v[60:61], s[30:31] op_sel:[0,1] op_sel_hi:[1,1]
    v_pk_mul_f32 v[62:63], v[62:63], s[30:31] op_sel:[0,1] op_sel_hi:[1,1]
    v_cvt_pk_bf16_f32 v88, v48, v49
    v_cvt_pk_bf16_f32 v89, v50, v51
    v_cvt_pk_bf16_f32 v90, v52, v53
    v_cvt_pk_bf16_f32 v91, v54, v55
    v_cvt_pk_bf16_f32 v92, v56, v57
    v_cvt_pk_bf16_f32 v93, v58, v59
    v_cvt_pk_bf16_f32 v94, v60, v61
    v_cvt_pk_bf16_f32 v95, v62, v63
    v_permlane32_swap_b32 v88, v90
    v_permlane32_swap_b32 v89, v91
    v_permlane32_swap_b32 v92, v94
    v_permlane32_swap_b32 v93, v95
    v_mov_b32 v98, s66
    v_mov_b32 v99, s67
    s_lshl_b32 s21, 1, s34
    s_add_u32 s21, s21, s28
    s_mov_b64 exec, s[48:49]
    s_cbranch_execz k1_kernel_nomix_18
    v_mov_b32 v96, v90
    v_mov_b32 v97, v91
    v_mov_b32 v90, v98
    v_mov_b32 v91, v99
    buffer_store_dwordx4 v[96:99], v100, s[16:19], s21 offen sc0 sc1
k1_kernel_nomix_18:
    s_mov_b64 exec, -1
    buffer_store_dwordx4 v[88:91], v100, s[16:19], s28 offen sc0 sc1
    s_mov_b64 exec, s[50:51]
    s_cbranch_execz k1_kernel_nomix_19
    v_mov_b32 v96, v94
    v_mov_b32 v97, v95
    v_mov_b32 v94, v98
    v_mov_b32 v95, v99
    buffer_store_dwordx4 v[96:99], v101, s[16:19], s21 offen sc0 sc1
k1_kernel_nomix_19:
    s_mov_b64 exec, -1
    buffer_store_dwordx4 v[92:95], v101, s[16:19], s28 offen sc0 sc1
    s_waitcnt vmcnt(0) lgkmcnt(0)
    s_branch k2_entry
k1_v1:
    s_add_u32 s20, s6, 0
    s_cmp_ge_u32 s20, 14
    s_cselect_b32 s21, 14, 0
    s_sub_u32 s20, s20, s21
    s_cmp_ge_u32 s21, 14
    s_cselect_b32 s32, 18, 17
    s_cselect_b32 s29, 1.0, 0x3e8b97f6
    s_cselect_b32 s62, 0x3f803f80, 0
    s_cselect_b32 s63, 0x3f80, 0
    s_cselect_b32 s21, 2097152, 0
    s_sub_u32 s22, s32, 6
    s_lshl_b32 s26, s23, s22
    s_add_u32 s26, s26, s21
    s_lshl_b32 s20, s20, 2
    v_lshrrev_b32 v5, 5, v0
    v_add3_u32 v5, v5, s20, 0
    v_mul_u32_u24 v6, 37, v5
    v_lshrrev_b32 v6, 8, v6
    v_add_u32 v5, v5, v6
    v_and_b32 v6, 7, v5
    v_cmp_eq_u32 s[40:41], 3, v6
    v_lshrrev_b32 v6, 2, v5
    v_lshlrev_b32 v6, s32, v6
    v_and_b32 v5, 3, v5
    v_lshl_add_u32 v6, v5, 9, v6
    v_and_b32 v5, 31, v0
    v_lshl_add_u32 v96, v5, 4, v6
    v_lshrrev_b32 v5, 5, v0
    v_add3_u32 v5, v5, s20, 2
    v_mul_u32_u24 v6, 37, v5
    v_lshrrev_b32 v6, 8, v6
    v_add_u32 v5, v5, v6
    v_and_b32 v6, 7, v5
    v_cmp_eq_u32 s[42:43], 3, v6
    v_lshrrev_b32 v6, 2, v5
    v_lshlrev_b32 v6, s32, v6
    v_and_b32 v5, 3, v5
    v_lshl_add_u32 v6, v5, 9, v6
    v_and_b32 v5, 31, v0
    v_lshl_add_u32 v97, v5, 4, v6
    s_add_u32 s20, s6, 1
    s_sub_u32 s20, s20, 28
    s_lshl_b32 s20, s20, 5
    v_and_b32 v5, 31, v0
    v_add_u32 v5, s20, v5
    v_mul_u32_u24 v6, 2341, v5
    v_lshrrev_b32 v6, 16, v6
    v_mul_u32_u24 v7, 28, v6
    v_sub_u32 v5, v5, v7
    v_and_b32 v7, 32, v0
    v_add_u32 v5, v5, v7
    v_lshlrev_b32 v5, 4, v5
    v_lshl_add_u32 v98, v6, 18, v5
    s_lshl_b32 s27, s23, 12
    s_add_u32 s27, s27, 2099200
    s_add_u32 s20, s6, 2
    s_sub_u32 s20, s20, 28
    s_lshl_b32 s20, s20, 5
    v_and_b32 v5, 31, v0
    v_add_u32 v5, s20, v5
    v_mul_u32_u24 v6, 2341, v5
    v_lshrrev_b32 v6, 16, v6
    v_mul_u32_u24 v7, 28, v6
    v_sub_u32 v5, v5, v7
    v_and_b32 v7, 32, v0
    v_add_u32 v5, v5, v7
    v_lshlrev_b32 v5, 4, v5
    v_lshl_add_u32 v100, v6, 18, v5
    s_lshl_b32 s28, s23, 12
    s_add_u32 s28, s28, 2099200
    s_mov_b32 s20, 0
    s_mov_b32 s21, 64
    v_lshrrev_b32 v5, 4, v0
    v_add_u32 v5, s20, v5
    v_mul_u32_u24 v6, 28, v5
    v_add_u32 v6, 27, v6
    v_cmp_gt_u32 s[56:57], s21, v6
    v_bfe_u32 v6, v0, 2, 2
    v_lshlrev_b32 v6, 9, v6
    v_lshl_add_u32 v6, v5, 18, v6
    v_and_b32 v5, 3, v0
    v_cmp_eq_u32 vcc, 0, v5
    v_lshl_add_u32 v6, v5, 4, v6
    v_add_u32 v102, 448, v6
    v_mov_b32 v5, 0x3f803f80
    v_cndmask_b32 v104, 0, v5, vcc
    v_cndmask_b32 v105, 0, v5, vcc
    v_cndmask_b32 v106, 0, v5, vcc
    v_cndmask_b32 v107, 0, v5, vcc
k1_kernel_poll_20:
    ds_read_b32 v5, v14 offset:0
    s_waitcnt lgkmcnt(0)
    v_readfirstlane_b32 s20, v5
    s_cmp_lt_u32 s20, 1
    s_cbranch_scc1 k1_kernel_poll_20
    ds_read_b128 v[64:67], v8 offset:0
    ds_read_b64_tr_b16 v[68:69], v12 offset:0
    ds_read_b64_tr_b16 v[70:71], v12 offset:768
    ds_read_b64_tr_b16 v[72:73], v12 offset:64
    ds_read_b64_tr_b16 v[74:75], v12 offset:832
    ds_read_b64_tr_b16 v[76:77], v12 offset:128
    ds_read_b64_tr_b16 v[78:79], v12 offset:896
    ds_read_b128 v[80:83], v9 offset:0
    ds_read_b64_tr_b16 v[84:85], v12 offset:3072
    ds_read_b64_tr_b16 v[86:87], v12 offset:3840
    ds_read_b64_tr_b16 v[88:89], v12 offset:3136
    ds_read_b64_tr_b16 v[90:91], v12 offset:3904
    ds_read_b64_tr_b16 v[92:93], v12 offset:3200
    ds_read_b64_tr_b16 v[94:95], v12 offset:3968
    ds_read_b32 v15, v14 offset:4
    ds_read_b128 v[128:131], v10 offset:0
    ds_read_b64_tr_b16 v[132:133], v12 offset:6144
    ds_read_b64_tr_b16 v[134:135], v12 offset:6912
    ds_read_b64_tr_b16 v[136:137], v12 offset:6208
    ds_read_b64_tr_b16 v[138:139], v12 offset:6976
    ds_read_b64_tr_b16 v[140:141], v12 offset:6272
    ds_read_b64_tr_b16 v[142:143], v12 offset:7040
    s_waitcnt lgkmcnt(15)
    v_mfma_f32_32x32x16_bf16 v[16:31], v[68:71], v[64:67], 0
    v_mfma_f32_32x32x16_bf16 v[32:47], v[64:67], v[72:75], 0
    v_mfma_f32_32x32x16_bf16 v[48:63], v[64:67], v[76:79], 0
    ds_read_b128 v[64:67], v11 offset:0
    ds_read_b64_tr_b16 v[68:69], v12 offset:9216
    ds_read_b64_tr_b16 v[70:71], v12 offset:9984
    ds_read_b64_tr_b16 v[72:73], v12 offset:9280
    ds_read_b64_tr_b16 v[74:75], v12 offset:10048
    ds_read_b64_tr_b16 v[76:77], v12 offset:9344
    ds_read_b64_tr_b16 v[78:79], v12 offset:10112
    s_waitcnt lgkmcnt(15)
    v_mfma_f32_32x32x16_bf16 v[16:31], v[84:87], v[80:83], v[16:31]
    v_mfma_f32_32x32x16_bf16 v[32:47], v[80:83], v[88:91], v[32:47]
    v_mfma_f32_32x32x16_bf16 v[48:63], v[80:83], v[92:95], v[48:63]
    s_waitcnt lgkmcnt(14)
    v_readfirstlane_b32 s35, v15
    s_cmp_ge_u32 s35, 1
    s_cbranch_scc1 k1_kernel_ok_21
k1_kernel_poll_22:
    ds_read_b32 v5, v14 offset:4
    s_waitcnt lgkmcnt(0)
    v_readfirstlane_b32 s20, v5
    s_cmp_lt_u32 s20, 1
    s_cbranch_scc1 k1_kernel_poll_22
k1_kernel_ok_21:
    ds_read_b128 v[80:83], v8 offset:28672
    ds_read_b64_tr_b16 v[84:85], v12 offset:28672
    ds_read_b64_tr_b16 v[86:87], v12 offset:29440
    ds_read_b64_tr_b16 v[88:89], v12 offset:28736
    ds_read_b64_tr_b16 v[90:91], v12 offset:29504
    ds_read_b64_tr_b16 v[92:93], v12 offset:28800
    ds_read_b64_tr_b16 v[94:95], v12 offset:29568
    s_waitcnt lgkmcnt(14)
    v_mfma_f32_32x32x16_bf16 v[16:31], v[132:135], v[128:131], v[16:31]
    v_mfma_f32_32x32x16_bf16 v[32:47], v[128:131], v[136:139], v[32:47]
    v_mfma_f32_32x32x16_bf16 v[48:63], v[128:131], v[140:143], v[48:63]
    ds_read_b128 v[128:131], v9 offset:28672
    ds_read_b64_tr_b16 v[132:133], v12 offset:31744
    ds_read_b64_tr_b16 v[134:135], v12 offset:32512
    ds_read_b64_tr_b16 v[136:137], v12 offset:31808
    ds_read_b64_tr_b16 v[138:139], v12 offset:32576
    ds_read_b64_tr_b16 v[140:141], v12 offset:31872
    ds_read_b64_tr_b16 v[142:143], v12 offset:32640
    s_waitcnt lgkmcnt(14)
    v_mfma_f32_32x32x16_bf16 v[16:31], v[68:71], v[64:67], v[16:31]
    v_mfma_f32_32x32x16_bf16 v[32:47], v[64:67], v[72:75], v[32:47]
    v_mfma_f32_32x32x16_bf16 v[48:63], v[64:67], v[76:79], v[48:63]
    s_mov_b64 exec, 1
    ds_add_u32 v14, v125 offset:40
    s_mov_b64 exec, -1
    ds_read_b32 v15, v14 offset:8
    ds_read_b128 v[64:67], v10 offset:28672
    ds_read_b64_tr_b16 v[68:69], v12 offset:34816
    ds_read_b64_tr_b16 v[70:71], v12 offset:35584
    ds_read_b64_tr_b16 v[72:73], v12 offset:34880
    ds_read_b64_tr_b16 v[74:75], v12 offset:35648
    ds_read_b64_tr_b16 v[76:77], v12 offset:34944
    ds_read_b64_tr_b16 v[78:79], v12 offset:35712
    s_waitcnt lgkmcnt(15)
    v_mfma_f32_32x32x16_bf16 v[16:31], v[84:87], v[80:83], v[16:31]
    v_mfma_f32_32x32x16_bf16 v[32:47], v[80:83], v[88:91], v[32:47]
    v_mfma_f32_32x32x16_bf16 v[48:63], v[80:83], v[92:95], v[48:63]
    ds_read_b128 v[80:83], v11 offset:28672
    ds_read_b64_tr_b16 v[84:85], v12 offset:37888
    ds_read_b64_tr_b16 v[86:87], v12 offset:38656
    ds_read_b64_tr_b16 v[88:89], v12 offset:37952
    ds_read_b64_tr_b16 v[90:91], v12 offset:38720
    ds_read_b64_tr_b16 v[92:93], v12 offset:38016
    ds_read_b64_tr_b16 v[94:95], v12 offset:38784
    s_waitcnt lgkmcnt(15)
    v_mfma_f32_32x32x16_bf16 v[16:31], v[132:135], v[128:131], v[16:31]
    v_mfma_f32_32x32x16_bf16 v[32:47], v[128:131], v[136:139], v[32:47]
    v_mfma_f32_32x32x16_bf16 v[48:63], v[128:131], v[140:143], v[48:63]
    s_waitcnt lgkmcnt(14)
    v_readfirstlane_b32 s35, v15
    s_cmp_ge_u32 s35, 1
    s_cbranch_scc1 k1_kernel_ok_23
k1_kernel_poll_24:
    ds_read_b32 v5, v14 offset:8
    s_waitcnt lgkmcnt(0)
    v_readfirstlane_b32 s20, v5
    s_cmp_lt_u32 s20, 1
    s_cbranch_scc1 k1_kernel_poll_24
k1_kernel_ok_23:
    ds_read_b128 v[128:131], v116 offset:0
    ds_read_b64_tr_b16 v[132:133], v13 offset:0
    ds_read_b64_tr_b16 v[134:135], v13 offset:768
    ds_read_b64_tr_b16 v[136:137], v13 offset:64
    ds_read_b64_tr_b16 v[138:139], v13 offset:832
    ds_read_b64_tr_b16 v[140:141], v13 offset:128
    ds_read_b64_tr_b16 v[142:143], v13 offset:896
    s_waitcnt lgkmcnt(14)
    v_mfma_f32_32x32x16_bf16 v[16:31], v[68:71], v[64:67], v[16:31]
    v_mfma_f32_32x32x16_bf16 v[32:47], v[64:67], v[72:75], v[32:47]
    v_mfma_f32_32x32x16_bf16 v[48:63], v[64:67], v[76:79], v[48:63]
    ds_read_b128 v[64:67], v117 offset:0
    ds_read_b64_tr_b16 v[68:69], v13 offset:3072
    ds_read_b64_tr_b16 v[70:71], v13 offset:3840
    ds_read_b64_tr_b16 v[72:73], v13 offset:3136
    ds_read_b64_tr_b16 v[74:75], v13 offset:3904
    ds_read_b64_tr_b16 v[76:77], v13 offset:3200
    ds_read_b64_tr_b16 v[78:79], v13 offset:3968
    s_waitcnt lgkmcnt(14)
    v_mfma_f32_32x32x16_bf16 v[16:31], v[84:87], v[80:83], v[16:31]
    v_mfma_f32_32x32x16_bf16 v[32:47], v[80:83], v[88:91], v[32:47]
    v_mfma_f32_32x32x16_bf16 v[48:63], v[80:83], v[92:95], v[48:63]
    s_mov_b64 exec, 1
    ds_add_u32 v14, v125 offset:44
    s_mov_b64 exec, -1
    ds_read_b32 v15, v14 offset:12
    ds_read_b128 v[80:83], v118 offset:0
    ds_read_b64_tr_b16 v[84:85], v13 offset:6144
    ds_read_b64_tr_b16 v[86:87], v13 offset:6912
    ds_read_b64_tr_b16 v[88:89], v13 offset:6208
    ds_read_b64_tr_b16 v[90:91], v13 offset:6976
    ds_read_b64_tr_b16 v[92:93], v13 offset:6272
    ds_read_b64_tr_b16 v[94:95], v13 offset:7040
    s_waitcnt lgkmcnt(15)
    v_mfma_f32_32x32x16_bf16 v[16:31], v[132:135], v[128:131], v[16:31]
    v_mfma_f32_32x32x16_bf16 v[32:47], v[128:131], v[136:139], v[32:47]
    v_mfma_f32_32x32x16_bf16 v[48:63], v[128:131], v[140:143], v[48:63]
    ds_read_b128 v[128:131], v119 offset:0
    ds_read_b64_tr_b16 v[132:133], v13 offset:9216
    ds_read_b64_tr_b16 v[134:135], v13 offset:9984
    ds_read_b64_tr_b16 v[136:137], v13 offset:9280
    ds_read_b64_tr_b16 v[138:139], v13 offset:10048
    ds_read_b64_tr_b16 v[140:141], v13 offset:9344
    ds_read_b64_tr_b16 v[142:143], v13 offset:10112
    s_waitcnt lgkmcnt(15)
    v_mfma_f32_32x32x16_bf16 v[16:31], v[68:71], v[64:67], v[16:31]
    v_mfma_f32_32x32x16_bf16 v[32:47], v[64:67], v[72:75], v[32:47]
    v_mfma_f32_32x32x16_bf16 v[48:63], v[64:67], v[76:79], v[48:63]
    s_waitcnt lgkmcnt(14)
    v_readfirstlane_b32 s35, v15
    s_cmp_ge_u32 s35, 1
    s_cbranch_scc1 k1_kernel_ok_25
k1_kernel_poll_26:
    ds_read_b32 v5, v14 offset:12
    s_waitcnt lgkmcnt(0)
    v_readfirstlane_b32 s20, v5
    s_cmp_lt_u32 s20, 1
    s_cbranch_scc1 k1_kernel_poll_26
k1_kernel_ok_25:
    ds_read_b128 v[64:67], v116 offset:28672
    ds_read_b64_tr_b16 v[68:69], v13 offset:28672
    ds_read_b64_tr_b16 v[70:71], v13 offset:29440
    ds_read_b64_tr_b16 v[72:73], v13 offset:28736
    ds_read_b64_tr_b16 v[74:75], v13 offset:29504
    ds_read_b64_tr_b16 v[76:77], v13 offset:28800
    ds_read_b64_tr_b16 v[78:79], v13 offset:29568
    s_waitcnt lgkmcnt(14)
    v_mfma_f32_32x32x16_bf16 v[16:31], v[84:87], v[80:83], v[16:31]
    v_mfma_f32_32x32x16_bf16 v[32:47], v[80:83], v[88:91], v[32:47]
    v_mfma_f32_32x32x16_bf16 v[48:63], v[80:83], v[92:95], v[48:63]
    ds_read_b128 v[80:83], v117 offset:28672
    ds_read_b64_tr_b16 v[84:85], v13 offset:31744
    ds_read_b64_tr_b16 v[86:87], v13 offset:32512
    ds_read_b64_tr_b16 v[88:89], v13 offset:31808
    ds_read_b64_tr_b16 v[90:91], v13 offset:32576
    ds_read_b64_tr_b16 v[92:93], v13 offset:31872
    ds_read_b64_tr_b16 v[94:95], v13 offset:32640
    s_waitcnt lgkmcnt(14)
    v_mfma_f32_32x32x16_bf16 v[16:31], v[132:135], v[128:131], v[16:31]
    v_mfma_f32_32x32x16_bf16 v[32:47], v[128:131], v[136:139], v[32:47]
    v_mfma_f32_32x32x16_bf16 v[48:63], v[128:131], v[140:143], v[48:63]
    s_mov_b64 exec, 1
    ds_add_u32 v14, v125 offset:48
    s_mov_b64 exec, -1
    ds_read_b32 v15, v14 offset:16
    ds_read_b128 v[128:131], v118 offset:28672
    ds_read_b64_tr_b16 v[132:133], v13 offset:34816
    ds_read_b64_tr_b16 v[134:135], v13 offset:35584
    ds_read_b64_tr_b16 v[136:137], v13 offset:34880
    ds_read_b64_tr_b16 v[138:139], v13 offset:35648
    ds_read_b64_tr_b16 v[140:141], v13 offset:34944
    ds_read_b64_tr_b16 v[142:143], v13 offset:35712
    s_waitcnt lgkmcnt(15)
    v_mfma_f32_32x32x16_bf16 v[16:31], v[68:71], v[64:67], v[16:31]
    v_mfma_f32_32x32x16_bf16 v[32:47], v[64:67], v[72:75], v[32:47]
    v_mfma_f32_32x32x16_bf16 v[48:63], v[64:67], v[76:79], v[48:63]
    ds_read_b128 v[64:67], v119 offset:28672
    ds_read_b64_tr_b16 v[68:69], v13 offset:37888
    ds_read_b64_tr_b16 v[70:71], v13 offset:38656
    ds_read_b64_tr_b16 v[72:73], v13 offset:37952
    ds_read_b64_tr_b16 v[74:75], v13 offset:38720
    ds_read_b64_tr_b16 v[76:77], v13 offset:38016
    ds_read_b64_tr_b16 v[78:79], v13 offset:38784
    s_waitcnt lgkmcnt(15)
    v_mfma_f32_32x32x16_bf16 v[16:31], v[84:87], v[80:83], v[16:31]
    v_mfma_f32_32x32x16_bf16 v[32:47], v[80:83], v[88:91], v[32:47]
    v_mfma_f32_32x32x16_bf16 v[48:63], v[80:83], v[92:95], v[48:63]
    s_waitcnt lgkmcnt(14)
    v_readfirstlane_b32 s35, v15
    s_cmp_ge_u32 s35, 1
    s_cbranch_scc1 k1_kernel_ok_27
k1_kernel_poll_28:
    ds_read_b32 v5, v14 offset:16
    s_waitcnt lgkmcnt(0)
    v_readfirstlane_b32 s20, v5
    s_cmp_lt_u32 s20, 1
    s_cbranch_scc1 k1_kernel_poll_28
k1_kernel_ok_27:
    ds_read_b128 v[80:83], v120 offset:0
    ds_read_b64_tr_b16 v[84:85], v124 offset:0
    ds_read_b64_tr_b16 v[86:87], v124 offset:768
    ds_read_b64_tr_b16 v[88:89], v124 offset:64
    ds_read_b64_tr_b16 v[90:91], v124 offset:832
    ds_read_b64_tr_b16 v[92:93], v124 offset:128
    ds_read_b64_tr_b16 v[94:95], v124 offset:896
    s_waitcnt lgkmcnt(14)
    v_mfma_f32_32x32x16_bf16 v[16:31], v[132:135], v[128:131], v[16:31]
    v_mfma_f32_32x32x16_bf16 v[32:47], v[128:131], v[136:139], v[32:47]
    v_mfma_f32_32x32x16_bf16 v[48:63], v[128:131], v[140:143], v[48:63]
    ds_read_b128 v[128:131], v121 offset:0
    ds_read_b64_tr_b16 v[132:133], v124 offset:3072
    ds_read_b64_tr_b16 v[134:135], v124 offset:3840
    ds_read_b64_tr_b16 v[136:137], v124 offset:3136
    ds_read_b64_tr_b16 v[138:139], v124 offset:3904
    ds_read_b64_tr_b16 v[140:141], v124 offset:3200
    ds_read_b64_tr_b16 v[142:143], v124 offset:3968
    s_waitcnt lgkmcnt(14)
    v_mfma_f32_32x32x16_bf16 v[16:31], v[68:71], v[64:67], v[16:31]
    v_mfma_f32_32x32x16_bf16 v[32:47], v[64:67], v[72:75], v[32:47]
    v_mfma_f32_32x32x16_bf16 v[48:63], v[64:67], v[76:79], v[48:63]
    ds_read_b32 v15, v14 offset:20
    ds_read_b128 v[64:67], v122 offset:0
    ds_read_b64_tr_b16 v[68:69], v124 offset:6144
    ds_read_b64_tr_b16 v[70:71], v124 offset:6912
    ds_read_b64_tr_b16 v[72:73], v124 offset:6208
    ds_read_b64_tr_b16 v[74:75], v124 offset:6976
    ds_read_b64_tr_b16 v[76:77], v124 offset:6272
    ds_read_b64_tr_b16 v[78:79], v124 offset:7040
    s_waitcnt lgkmcnt(15)
    v_mfma_f32_32x32x16_bf16 v[16:31], v[84:87], v[80:83], v[16:31]
    v_mfma_f32_32x32x16_bf16 v[32:47], v[80:83], v[88:91], v[32:47]
    v_mfma_f32_32x32x16_bf16 v[48:63], v[80:83], v[92:95], v[48:63]
    ds_read_b128 v[80:83], v123 offset:0
    ds_read_b64_tr_b16 v[84:85], v124 offset:9216
    ds_read_b64_tr_b16 v[86:87], v124 offset:9984
    ds_read_b64_tr_b16 v[88:89], v124 offset:9280
    ds_read_b64_tr_b16 v[90:91], v124 offset:10048
    ds_read_b64_tr_b16 v[92:93], v124 offset:9344
    ds_read_b64_tr_b16 v[94:95], v124 offset:10112
    s_waitcnt lgkmcnt(15)
    v_mfma_f32_32x32x16_bf16 v[16:31], v[132:135], v[128:131], v[16:31]
    v_mfma_f32_32x32x16_bf16 v[32:47], v[128:131], v[136:139], v[32:47]
    v_mfma_f32_32x32x16_bf16 v[48:63], v[128:131], v[140:143], v[48:63]
    s_waitcnt lgkmcnt(14)
    v_readfirstlane_b32 s35, v15
    s_cmp_ge_u32 s35, 1
    s_cbranch_scc1 k1_kernel_ok_29
k1_kernel_poll_30:
    ds_read_b32 v5, v14 offset:20
    s_waitcnt lgkmcnt(0)
    v_readfirstlane_b32 s20, v5
    s_cmp_lt_u32 s20, 1
    s_cbranch_scc1 k1_kernel_poll_30
k1_kernel_ok_29:
    ds_read_b128 v[128:131], v8 offset:0
    ds_read_b64_tr_b16 v[132:133], v12 offset:0
    ds_read_b64_tr_b16 v[134:135], v12 offset:768
    ds_read_b64_tr_b16 v[136:137], v12 offset:64
    ds_read_b64_tr_b16 v[138:139], v12 offset:832
    ds_read_b64_tr_b16 v[140:141], v12 offset:128
    ds_read_b64_tr_b16 v[142:143], v12 offset:896
    s_waitcnt lgkmcnt(14)
    v_mfma_f32_32x32x16_bf16 v[16:31], v[68:71], v[64:67], v[16:31]
    v_mfma_f32_32x32x16_bf16 v[32:47], v[64:67], v[72:75], v[32:47]
    v_mfma_f32_32x32x16_bf16 v[48:63], v[64:67], v[76:79], v[48:63]
    ds_read_b128 v[64:67], v9 offset:0
    ds_read_b64_tr_b16 v[68:69], v12 offset:3072
    ds_read_b64_tr_b16 v[70:71], v12 offset:3840
    ds_read_b64_tr_b16 v[72:73], v12 offset:3136
    ds_read_b64_tr_b16 v[74:75], v12 offset:3904
    ds_read_b64_tr_b16 v[76:77], v12 offset:3200
    ds_read_b64_tr_b16 v[78:79], v12 offset:3968
    s_waitcnt lgkmcnt(14)
    v_mfma_f32_32x32x16_bf16 v[16:31], v[84:87], v[80:83], v[16:31]
    v_mfma_f32_32x32x16_bf16 v[32:47], v[80:83], v[88:91], v[32:47]
    v_mfma_f32_32x32x16_bf16 v[48:63], v[80:83], v[92:95], v[48:63]
    ds_read_b32 v15, v14 offset:24
    ds_read_b128 v[80:83], v10 offset:0
    ds_read_b64_tr_b16 v[84:85], v12 offset:6144
    ds_read_b64_tr_b16 v[86:87], v12 offset:6912
    ds_read_b64_tr_b16 v[88:89], v12 offset:6208
    ds_read_b64_tr_b16 v[90:91], v12 offset:6976
    ds_read_b64_tr_b16 v[92:93], v12 offset:6272
    ds_read_b64_tr_b16 v[94:95], v12 offset:7040
    s_waitcnt lgkmcnt(15)
    v_mfma_f32_32x32x16_bf16 v[16:31], v[132:135], v[128:131], v[16:31]
    v_mfma_f32_32x32x16_bf16 v[32:47], v[128:131], v[136:139], v[32:47]
    v_mfma_f32_32x32x16_bf16 v[48:63], v[128:131], v[140:143], v[48:63]
    ds_read_b128 v[128:131], v11 offset:0
    ds_read_b64_tr_b16 v[132:133], v12 offset:9216
    ds_read_b64_tr_b16 v[134:135], v12 offset:9984
    ds_read_b64_tr_b16 v[136:137], v12 offset:9280
    ds_read_b64_tr_b16 v[138:139], v12 offset:10048
    ds_read_b64_tr_b16 v[140:141], v12 offset:9344
    ds_read_b64_tr_b16 v[142:143], v12 offset:10112
    s_waitcnt lgkmcnt(15)
    v_mfma_f32_32x32x16_bf16 v[16:31], v[68:71], v[64:67], v[16:31]
    v_mfma_f32_32x32x16_bf16 v[32:47], v[64:67], v[72:75], v[32:47]
    v_mfma_f32_32x32x16_bf16 v[48:63], v[64:67], v[76:79], v[48:63]
    s_waitcnt lgkmcnt(14)
    v_readfirstlane_b32 s35, v15
    s_cmp_ge_u32 s35, 1
    s_cbranch_scc1 k1_kernel_ok_31
k1_kernel_poll_32:
    ds_read_b32 v5, v14 offset:24
    s_waitcnt lgkmcnt(0)
    v_readfirstlane_b32 s20, v5
    s_cmp_lt_u32 s20, 1
    s_cbranch_scc1 k1_kernel_poll_32
k1_kernel_ok_31:
    ds_read_b128 v[64:67], v8 offset:28672
    ds_read_b64_tr_b16 v[68:69], v12 offset:28672
    ds_read_b64_tr_b16 v[70:71], v12 offset:29440
    ds_read_b64_tr_b16 v[72:73], v12 offset:28736
    ds_read_b64_tr_b16 v[74:75], v12 offset:29504
    ds_read_b64_tr_b16 v[76:77], v12 offset:28800
    ds_read_b64_tr_b16 v[78:79], v12 offset:29568
    s_waitcnt lgkmcnt(14)
    v_mfma_f32_32x32x16_bf16 v[16:31], v[84:87], v[80:83], v[16:31]
    v_mfma_f32_32x32x16_bf16 v[32:47], v[80:83], v[88:91], v[32:47]
    v_mfma_f32_32x32x16_bf16 v[48:63], v[80:83], v[92:95], v[48:63]
    ds_read_b128 v[80:83], v9 offset:28672
    ds_read_b64_tr_b16 v[84:85], v12 offset:31744
    ds_read_b64_tr_b16 v[86:87], v12 offset:32512
    ds_read_b64_tr_b16 v[88:89], v12 offset:31808
    ds_read_b64_tr_b16 v[90:91], v12 offset:32576
    ds_read_b64_tr_b16 v[92:93], v12 offset:31872
    ds_read_b64_tr_b16 v[94:95], v12 offset:32640
    s_waitcnt lgkmcnt(14)
    v_mfma_f32_32x32x16_bf16 v[16:31], v[132:135], v[128:131], v[16:31]
    v_mfma_f32_32x32x16_bf16 v[32:47], v[128:131], v[136:139], v[32:47]
    v_mfma_f32_32x32x16_bf16 v[48:63], v[128:131], v[140:143], v[48:63]
    ds_read_b128 v[128:131], v10 offset:28672
    ds_read_b64_tr_b16 v[132:133], v12 offset:34816
    ds_read_b64_tr_b16 v[134:135], v12 offset:35584
    ds_read_b64_tr_b16 v[136:137], v12 offset:34880
    ds_read_b64_tr_b16 v[138:139], v12 offset:35648
    ds_read_b64_tr_b16 v[140:141], v12 offset:34944
    ds_read_b64_tr_b16 v[142:143], v12 offset:35712
    s_waitcnt lgkmcnt(14)
    v_mfma_f32_32x32x16_bf16 v[16:31], v[68:71], v[64:67], v[16:31]
    v_mfma_f32_32x32x16_bf16 v[32:47], v[64:67], v[72:75], v[32:47]
    v_mfma_f32_32x32x16_bf16 v[48:63], v[64:67], v[76:79], v[48:63]
    ds_read_b128 v[64:67], v11 offset:28672
    ds_read_b64_tr_b16 v[68:69], v12 offset:37888
    ds_read_b64_tr_b16 v[70:71], v12 offset:38656
    ds_read_b64_tr_b16 v[72:73], v12 offset:37952
    ds_read_b64_tr_b16 v[74:75], v12 offset:38720
    ds_read_b64_tr_b16 v[76:77], v12 offset:38016
    ds_read_b64_tr_b16 v[78:79], v12 offset:38784
    s_waitcnt lgkmcnt(14)
    v_mfma_f32_32x32x16_bf16 v[16:31], v[84:87], v[80:83], v[16:31]
    v_mfma_f32_32x32x16_bf16 v[32:47], v[80:83], v[88:91], v[32:47]
    v_mfma_f32_32x32x16_bf16 v[48:63], v[80:83], v[92:95], v[48:63]
    s_waitcnt lgkmcnt(7)
    v_mfma_f32_32x32x16_bf16 v[16:31], v[132:135], v[128:131], v[16:31]
    v_mfma_f32_32x32x16_bf16 v[32:47], v[128:131], v[136:139], v[32:47]
    v_mfma_f32_32x32x16_bf16 v[48:63], v[128:131], v[140:143], v[48:63]
    s_waitcnt lgkmcnt(0)
    v_mfma_f32_32x32x16_bf16 v[16:31], v[68:71], v[64:67], v[16:31]
    v_mfma_f32_32x32x16_bf16 v[32:47], v[64:67], v[72:75], v[32:47]
    v_mfma_f32_32x32x16_bf16 v[48:63], v[64:67], v[76:79], v[48:63]
    s_mov_b64 exec, s[56:57]
    buffer_store_dwordx4 v[104:107], v102, s[16:19], s28 offen sc0 sc1
    s_mov_b64 exec, -1
    s_nop 6
    v_pk_mul_f32 v[16:17], v[16:17], s[28:29] op_sel:[0,1] op_sel_hi:[1,1]
    v_pk_mul_f32 v[18:19], v[18:19], s[28:29] op_sel:[0,1] op_sel_hi:[1,1]
    v_pk_mul_f32 v[20:21], v[20:21], s[28:29] op_sel:[0,1] op_sel_hi:[1,1]
    v_pk_mul_f32 v[22:23], v[22:23], s[28:29] op_sel:[0,1] op_sel_hi:[1,1]
    v_pk_mul_f32 v[24:25], v[24:25], s[28:29] op_sel:[0,1] op_sel_hi:[1,1]
    v_pk_mul_f32 v[26:27], v[26:27], s[28:29] op_sel:[0,1] op_sel_hi:[1,1]
    v_pk_mul_f32 v[28:29], v[28:29], s[28:29] op_sel:[0,1] op_sel_hi:[1,1]
    v_pk_mul_f32 v[30:31], v[30:31], s[28:29] op_sel:[0,1] op_sel_hi:[1,1]
    v_cvt_pk_bf16_f32 v64, v16, v17
    v_cvt_pk_bf16_f32 v65, v18, v19
    v_cvt_pk_bf16_f32 v66, v20, v21
    v_cvt_pk_bf16_f32 v67, v22, v23
    v_cvt_pk_bf16_f32 v68, v24, v25
    v_cvt_pk_bf16_f32 v69, v26, v27
    v_cvt_pk_bf16_f32 v70, v28, v29
    v_cvt_pk_bf16_f32 v71, v30, v31
    v_permlane32_swap_b32 v64, v66
    v_permlane32_swap_b32 v65, v67
    v_permlane32_swap_b32 v68, v70
    v_permlane32_swap_b32 v69, v71
    v_mov_b32 v74, s62
    v_mov_b32 v75, s63
    s_lshl_b32 s21, 1, s32
    s_add_u32 s21, s21, s26
    s_mov_b64 exec, s[40:41]
    s_cbranch_execz k1_kernel_nomix_33
    v_mov_b32 v72, v66
    v_mov_b32 v73, v67
    v_mov_b32 v66, v74
    v_mov_b32 v67, v75
    buffer_store_dwordx4 v[72:75], v96, s[16:19], s21 offen sc0 sc1
k1_kernel_nomix_33:
    s_mov_b64 exec, -1
    buffer_store_dwordx4 v[64:67], v96, s[16:19], s26 offen sc0 sc1
    s_mov_b64 exec, s[42:43]
    s_cbranch_execz k1_kernel_nomix_34
    v_mov_b32 v72, v70
    v_mov_b32 v73, v71
    v_mov_b32 v70, v74
    v_mov_b32 v71, v75
    buffer_store_dwordx4 v[72:75], v97, s[16:19], s21 offen sc0 sc1
k1_kernel_nomix_34:
    s_mov_b64 exec, -1
    buffer_store_dwordx4 v[68:71], v97, s[16:19], s26 offen sc0 sc1
    v_cvt_pk_bf16_f32 v76, v32, v33
    v_cvt_pk_bf16_f32 v77, v34, v35
    v_cvt_pk_bf16_f32 v78, v36, v37
    v_cvt_pk_bf16_f32 v79, v38, v39
    v_cvt_pk_bf16_f32 v80, v40, v41
    v_cvt_pk_bf16_f32 v81, v42, v43
    v_cvt_pk_bf16_f32 v82, v44, v45
    v_cvt_pk_bf16_f32 v83, v46, v47
    buffer_store_dwordx4 v[76:79], v98, s[16:19], s27 offen sc0 sc1
    buffer_store_dwordx4 v[80:83], v98, s[16:19], s27 offen offset:1024 sc0 sc1
    v_cvt_pk_bf16_f32 v88, v48, v49
    v_cvt_pk_bf16_f32 v89, v50, v51
    v_cvt_pk_bf16_f32 v90, v52, v53
    v_cvt_pk_bf16_f32 v91, v54, v55
    v_cvt_pk_bf16_f32 v92, v56, v57
    v_cvt_pk_bf16_f32 v93, v58, v59
    v_cvt_pk_bf16_f32 v94, v60, v61
    v_cvt_pk_bf16_f32 v95, v62, v63
    buffer_store_dwordx4 v[88:91], v100, s[16:19], s28 offen sc0 sc1
    buffer_store_dwordx4 v[92:95], v100, s[16:19], s28 offen offset:1024 sc0 sc1
    s_waitcnt vmcnt(0) lgkmcnt(0)
    s_branch k2_entry
k1_v2:
    s_add_u32 s20, s6, 0
    s_sub_u32 s20, s20, 28
    s_lshl_b32 s20, s20, 5
    v_and_b32 v5, 31, v0
    v_add_u32 v5, s20, v5
    v_mul_u32_u24 v6, 2341, v5
    v_lshrrev_b32 v6, 16, v6
    v_mul_u32_u24 v7, 28, v6
    v_sub_u32 v5, v5, v7
    v_and_b32 v7, 32, v0
    v_add_u32 v5, v5, v7
    v_lshlrev_b32 v5, 4, v5
    v_lshl_add_u32 v96, v6, 18, v5
    s_lshl_b32 s26, s23, 12
    s_add_u32 s26, s26, 2099200
    s_add_u32 s20, s6, 1
    s_sub_u32 s20, s20, 28
    s_lshl_b32 s20, s20, 5
    v_and_b32 v5, 31, v0
    v_add_u32 v5, s20, v5
    v_mul_u32_u24 v6, 2341, v5
    v_lshrrev_b32 v6, 16, v6
    v_mul_u32_u24 v7, 28, v6
    v_sub_u32 v5, v5, v7
    v_and_b32 v7, 32, v0
    v_add_u32 v5, v5, v7
    v_lshlrev_b32 v5, 4, v5
    v_lshl_add_u32 v98, v6, 18, v5
    s_lshl_b32 s27, s23, 12
    s_add_u32 s27, s27, 2099200
    s_add_u32 s20, s6, 2
    s_sub_u32 s20, s20, 28
    s_lshl_b32 s20, s20, 5
    v_and_b32 v5, 31, v0
    v_add_u32 v5, s20, v5
    v_mul_u32_u24 v6, 2341, v5
    v_lshrrev_b32 v6, 16, v6
    v_mul_u32_u24 v7, 28, v6
    v_sub_u32 v5, v5, v7
    v_and_b32 v7, 32, v0
    v_add_u32 v5, v5, v7
    v_lshlrev_b32 v5, 4, v5
    v_lshl_add_u32 v100, v6, 18, v5
    s_lshl_b32 s28, s23, 12
    s_add_u32 s28, s28, 2099200
    s_mul_i32 s20, s4, 96
    s_sub_u32 s20, s20, 896
    s_add_u32 s21, s20, 96
    s_mul_i32 s20, s20, 2341
    s_lshr_b32 s20, s20, 16
    v_lshrrev_b32 v5, 4, v0
    v_add_u32 v5, s20, v5
    v_mul_u32_u24 v6, 28, v5
    v_add_u32 v6, 27, v6
    v_cmp_gt_u32 s[56:57], s21, v6
    v_bfe_u32 v6, v0, 2, 2
    v_lshlrev_b32 v6, 9, v6
    v_lshl_add_u32 v6, v5, 18, v6
    v_and_b32 v5, 3, v0
    v_cmp_eq_u32 vcc, 0, v5
    v_lshl_add_u32 v6, v5, 4, v6
    v_add_u32 v102, 448, v6
    v_mov_b32 v5, 0x3f803f80
    v_cndmask_b32 v104, 0, v5, vcc
    v_cndmask_b32 v105, 0, v5, vcc
    v_cndmask_b32 v106, 0, v5, vcc
    v_cndmask_b32 v107, 0, v5, vcc
k1_kernel_poll_35:
    ds_read_b32 v5, v14 offset:0
    s_waitcnt lgkmcnt(0)
    v_readfirstlane_b32 s20, v5
    s_cmp_lt_u32 s20, 1
    s_cbranch_scc1 k1_kernel_poll_35
    ds_read_b128 v[64:67], v8 offset:0
    ds_read_b64_tr_b16 v[68:69], v12 offset:0
    ds_read_b64_tr_b16 v[70:71], v12 offset:768
    ds_read_b64_tr_b16 v[72:73], v12 offset:64
    ds_read_b64_tr_b16 v[74:75], v12 offset:832
    ds_read_b64_tr_b16 v[76:77], v12 offset:128
    ds_read_b64_tr_b16 v[78:79], v12 offset:896
    ds_read_b128 v[80:83], v9 offset:0
    ds_read_b64_tr_b16 v[84:85], v12 offset:3072
    ds_read_b64_tr_b16 v[86:87], v12 offset:3840
    ds_read_b64_tr_b16 v[88:89], v12 offset:3136
    ds_read_b64_tr_b16 v[90:91], v12 offset:3904
    ds_read_b64_tr_b16 v[92:93], v12 offset:3200
    ds_read_b64_tr_b16 v[94:95], v12 offset:3968
    ds_read_b32 v15, v14 offset:4
    ds_read_b128 v[128:131], v10 offset:0
    ds_read_b64_tr_b16 v[132:133], v12 offset:6144
    ds_read_b64_tr_b16 v[134:135], v12 offset:6912
    ds_read_b64_tr_b16 v[136:137], v12 offset:6208
    ds_read_b64_tr_b16 v[138:139], v12 offset:6976
    ds_read_b64_tr_b16 v[140:141], v12 offset:6272
    ds_read_b64_tr_b16 v[142:143], v12 offset:7040
    s_waitcnt lgkmcnt(15)
    v_mfma_f32_32x32x16_bf16 v[16:31], v[64:67], v[68:71], 0
    v_mfma_f32_32x32x16_bf16 v[32:47], v[64:67], v[72:75], 0
    v_mfma_f32_32x32x16_bf16 v[48:63], v[64:67], v[76:79], 0
    ds_read_b128 v[64:67], v11 offset:0
    ds_read_b64_tr_b16 v[68:69], v12 offset:9216
    ds_read_b64_tr_b16 v[70:71], v12 offset:9984
    ds_read_b64_tr_b16 v[72:73], v12 offset:9280
    ds_read_b64_tr_b16 v[74:75], v12 offset:10048
    ds_read_b64_tr_b16 v[76:77], v12 offset:9344
    ds_read_b64_tr_b16 v[78:79], v12 offset:10112
    s_waitcnt lgkmcnt(15)
    v_mfma_f32_32x32x16_bf16 v[16:31], v[80:83], v[84:87], v[16:31]
    v_mfma_f32_32x32x16_bf16 v[32:47], v[80:83], v[88:91], v[32:47]
    v_mfma_f32_32x32x16_bf16 v[48:63], v[80:83], v[92:95], v[48:63]
    s_waitcnt lgkmcnt(14)
    v_readfirstlane_b32 s35, v15
    s_cmp_ge_u32 s35, 1
    s_cbranch_scc1 k1_kernel_ok_36
k1_kernel_poll_37:
    ds_read_b32 v5, v14 offset:4
    s_waitcnt lgkmcnt(0)
    v_readfirstlane_b32 s20, v5
    s_cmp_lt_u32 s20, 1
    s_cbranch_scc1 k1_kernel_poll_37
k1_kernel_ok_36:
    ds_read_b128 v[80:83], v8 offset:28672
    ds_read_b64_tr_b16 v[84:85], v12 offset:28672
    ds_read_b64_tr_b16 v[86:87], v12 offset:29440
    ds_read_b64_tr_b16 v[88:89], v12 offset:28736
    ds_read_b64_tr_b16 v[90:91], v12 offset:29504
    ds_read_b64_tr_b16 v[92:93], v12 offset:28800
    ds_read_b64_tr_b16 v[94:95], v12 offset:29568
    s_waitcnt lgkmcnt(14)
    v_mfma_f32_32x32x16_bf16 v[16:31], v[128:131], v[132:135], v[16:31]
    v_mfma_f32_32x32x16_bf16 v[32:47], v[128:131], v[136:139], v[32:47]
    v_mfma_f32_32x32x16_bf16 v[48:63], v[128:131], v[140:143], v[48:63]
    ds_read_b128 v[128:131], v9 offset:28672
    ds_read_b64_tr_b16 v[132:133], v12 offset:31744
    ds_read_b64_tr_b16 v[134:135], v12 offset:32512
    ds_read_b64_tr_b16 v[136:137], v12 offset:31808
    ds_read_b64_tr_b16 v[138:139], v12 offset:32576
    ds_read_b64_tr_b16 v[140:141], v12 offset:31872
    ds_read_b64_tr_b16 v[142:143], v12 offset:32640
    s_waitcnt lgkmcnt(14)
    v_mfma_f32_32x32x16_bf16 v[16:31], v[64:67], v[68:71], v[16:31]
    v_mfma_f32_32x32x16_bf16 v[32:47], v[64:67], v[72:75], v[32:47]
    v_mfma_f32_32x32x16_bf16 v[48:63], v[64:67], v[76:79], v[48:63]
    s_mov_b64 exec, 1
    ds_add_u32 v14, v125 offset:40
    s_mov_b64 exec, -1
    ds_read_b32 v15, v14 offset:8
    ds_read_b128 v[64:67], v10 offset:28672
    ds_read_b64_tr_b16 v[68:69], v12 offset:34816
    ds_read_b64_tr_b16 v[70:71], v12 offset:35584
    ds_read_b64_tr_b16 v[72:73], v12 offset:34880
    ds_read_b64_tr_b16 v[74:75], v12 offset:35648
    ds_read_b64_tr_b16 v[76:77], v12 offset:34944
    ds_read_b64_tr_b16 v[78:79], v12 offset:35712
    s_waitcnt lgkmcnt(15)
    v_mfma_f32_32x32x16_bf16 v[16:31], v[80:83], v[84:87], v[16:31]
    v_mfma_f32_32x32x16_bf16 v[32:47], v[80:83], v[88:91], v[32:47]
    v_mfma_f32_32x32x16_bf16 v[48:63], v[80:83], v[92:95], v[48:63]
    ds_read_b128 v[80:83], v11 offset:28672
    ds_read_b64_tr_b16 v[84:85], v12 offset:37888
    ds_read_b64_tr_b16 v[86:87], v12 offset:38656
    ds_read_b64_tr_b16 v[88:89], v12 offset:37952
    ds_read_b64_tr_b16 v[90:91], v12 offset:38720
    ds_read_b64_tr_b16 v[92:93], v12 offset:38016
    ds_read_b64_tr_b16 v[94:95], v12 offset:38784
    s_waitcnt lgkmcnt(15)
    v_mfma_f32_32x32x16_bf16 v[16:31], v[128:131], v[132:135], v[16:31]
    v_mfma_f32_32x32x16_bf16 v[32:47], v[128:131], v[136:139], v[32:47]
    v_mfma_f32_32x32x16_bf16 v[48:63], v[128:131], v[140:143], v[48:63]
    s_waitcnt lgkmcnt(14)
    v_readfirstlane_b32 s35, v15
    s_cmp_ge_u32 s35, 1
    s_cbranch_scc1 k1_kernel_ok_38
k1_kernel_poll_39:
    ds_read_b32 v5, v14 offset:8
    s_waitcnt lgkmcnt(0)
    v_readfirstlane_b32 s20, v5
    s_cmp_lt_u32 s20, 1
    s_cbranch_scc1 k1_kernel_poll_39
k1_kernel_ok_38:
    ds_read_b128 v[128:131], v116 offset:0
    ds_read_b64_tr_b16 v[132:133], v13 offset:0
    ds_read_b64_tr_b16 v[134:135], v13 offset:768
    ds_read_b64_tr_b16 v[136:137], v13 offset:64
    ds_read_b64_tr_b16 v[138:139], v13 offset:832
    ds_read_b64_tr_b16 v[140:141], v13 offset:128
    ds_read_b64_tr_b16 v[142:143], v13 offset:896
    s_waitcnt lgkmcnt(14)
    v_mfma_f32_32x32x16_bf16 v[16:31], v[64:67], v[68:71], v[16:31]
    v_mfma_f32_32x32x16_bf16 v[32:47], v[64:67], v[72:75], v[32:47]
    v_mfma_f32_32x32x16_bf16 v[48:63], v[64:67], v[76:79], v[48:63]
    ds_read_b128 v[64:67], v117 offset:0
    ds_read_b64_tr_b16 v[68:69], v13 offset:3072
    ds_read_b64_tr_b16 v[70:71], v13 offset:3840
    ds_read_b64_tr_b16 v[72:73], v13 offset:3136
    ds_read_b64_tr_b16 v[74:75], v13 offset:3904
    ds_read_b64_tr_b16 v[76:77], v13 offset:3200
    ds_read_b64_tr_b16 v[78:79], v13 offset:3968
    s_waitcnt lgkmcnt(14)
    v_mfma_f32_32x32x16_bf16 v[16:31], v[80:83], v[84:87], v[16:31]
    v_mfma_f32_32x32x16_bf16 v[32:47], v[80:83], v[88:91], v[32:47]
    v_mfma_f32_32x32x16_bf16 v[48:63], v[80:83], v[92:95], v[48:63]
    s_mov_b64 exec, 1
    ds_add_u32 v14, v125 offset:44
    s_mov_b64 exec, -1
    ds_read_b32 v15, v14 offset:12
    ds_read_b128 v[80:83], v118 offset:0
    ds_read_b64_tr_b16 v[84:85], v13 offset:6144
    ds_read_b64_tr_b16 v[86:87], v13 offset:6912
    ds_read_b64_tr_b16 v[88:89], v13 offset:6208
    ds_read_b64_tr_b16 v[90:91], v13 offset:6976
    ds_read_b64_tr_b16 v[92:93], v13 offset:6272
    ds_read_b64_tr_b16 v[94:95], v13 offset:7040
    s_waitcnt lgkmcnt(15)
    v_mfma_f32_32x32x16_bf16 v[16:31], v[128:131], v[132:135], v[16:31]
    v_mfma_f32_32x32x16_bf16 v[32:47], v[128:131], v[136:139], v[32:47]
    v_mfma_f32_32x32x16_bf16 v[48:63], v[128:131], v[140:143], v[48:63]
    ds_read_b128 v[128:131], v119 offset:0
    ds_read_b64_tr_b16 v[132:133], v13 offset:9216
    ds_read_b64_tr_b16 v[134:135], v13 offset:9984
    ds_read_b64_tr_b16 v[136:137], v13 offset:9280
    ds_read_b64_tr_b16 v[138:139], v13 offset:10048
    ds_read_b64_tr_b16 v[140:141], v13 offset:9344
    ds_read_b64_tr_b16 v[142:143], v13 offset:10112
    s_waitcnt lgkmcnt(15)
    v_mfma_f32_32x32x16_bf16 v[16:31], v[64:67], v[68:71], v[16:31]
    v_mfma_f32_32x32x16_bf16 v[32:47], v[64:67], v[72:75], v[32:47]
    v_mfma_f32_32x32x16_bf16 v[48:63], v[64:67], v[76:79], v[48:63]
    s_waitcnt lgkmcnt(14)
    v_readfirstlane_b32 s35, v15
    s_cmp_ge_u32 s35, 1
    s_cbranch_scc1 k1_kernel_ok_40
k1_kernel_poll_41:
    ds_read_b32 v5, v14 offset:12
    s_waitcnt lgkmcnt(0)
    v_readfirstlane_b32 s20, v5
    s_cmp_lt_u32 s20, 1
    s_cbranch_scc1 k1_kernel_poll_41
k1_kernel_ok_40:
    ds_read_b128 v[64:67], v116 offset:28672
    ds_read_b64_tr_b16 v[68:69], v13 offset:28672
    ds_read_b64_tr_b16 v[70:71], v13 offset:29440
    ds_read_b64_tr_b16 v[72:73], v13 offset:28736
    ds_read_b64_tr_b16 v[74:75], v13 offset:29504
    ds_read_b64_tr_b16 v[76:77], v13 offset:28800
    ds_read_b64_tr_b16 v[78:79], v13 offset:29568
    s_waitcnt lgkmcnt(14)
    v_mfma_f32_32x32x16_bf16 v[16:31], v[80:83], v[84:87], v[16:31]
    v_mfma_f32_32x32x16_bf16 v[32:47], v[80:83], v[88:91], v[32:47]
    v_mfma_f32_32x32x16_bf16 v[48:63], v[80:83], v[92:95], v[48:63]
    ds_read_b128 v[80:83], v117 offset:28672
    ds_read_b64_tr_b16 v[84:85], v13 offset:31744
    ds_read_b64_tr_b16 v[86:87], v13 offset:32512
    ds_read_b64_tr_b16 v[88:89], v13 offset:31808
    ds_read_b64_tr_b16 v[90:91], v13 offset:32576
    ds_read_b64_tr_b16 v[92:93], v13 offset:31872
    ds_read_b64_tr_b16 v[94:95], v13 offset:32640
    s_waitcnt lgkmcnt(14)
    v_mfma_f32_32x32x16_bf16 v[16:31], v[128:131], v[132:135], v[16:31]
    v_mfma_f32_32x32x16_bf16 v[32:47], v[128:131], v[136:139], v[32:47]
    v_mfma_f32_32x32x16_bf16 v[48:63], v[128:131], v[140:143], v[48:63]
    s_mov_b64 exec, 1
    ds_add_u32 v14, v125 offset:48
    s_mov_b64 exec, -1
    ds_read_b32 v15, v14 offset:16
    ds_read_b128 v[128:131], v118 offset:28672
    ds_read_b64_tr_b16 v[132:133], v13 offset:34816
    ds_read_b64_tr_b16 v[134:135], v13 offset:35584
    ds_read_b64_tr_b16 v[136:137], v13 offset:34880
    ds_read_b64_tr_b16 v[138:139], v13 offset:35648
    ds_read_b64_tr_b16 v[140:141], v13 offset:34944
    ds_read_b64_tr_b16 v[142:143], v13 offset:35712
    s_waitcnt lgkmcnt(15)
    v_mfma_f32_32x32x16_bf16 v[16:31], v[64:67], v[68:71], v[16:31]
    v_mfma_f32_32x32x16_bf16 v[32:47], v[64:67], v[72:75], v[32:47]
    v_mfma_f32_32x32x16_bf16 v[48:63], v[64:67], v[76:79], v[48:63]
    ds_read_b128 v[64:67], v119 offset:28672
    ds_read_b64_tr_b16 v[68:69], v13 offset:37888
    ds_read_b64_tr_b16 v[70:71], v13 offset:38656
    ds_read_b64_tr_b16 v[72:73], v13 offset:37952
    ds_read_b64_tr_b16 v[74:75], v13 offset:38720
    ds_read_b64_tr_b16 v[76:77], v13 offset:38016
    ds_read_b64_tr_b16 v[78:79], v13 offset:38784
    s_waitcnt lgkmcnt(15)
    v_mfma_f32_32x32x16_bf16 v[16:31], v[80:83], v[84:87], v[16:31]
    v_mfma_f32_32x32x16_bf16 v[32:47], v[80:83], v[88:91], v[32:47]
    v_mfma_f32_32x32x16_bf16 v[48:63], v[80:83], v[92:95], v[48:63]
    s_waitcnt lgkmcnt(14)
    v_readfirstlane_b32 s35, v15
    s_cmp_ge_u32 s35, 1
    s_cbranch_scc1 k1_kernel_ok_42
k1_kernel_poll_43:
    ds_read_b32 v5, v14 offset:16
    s_waitcnt lgkmcnt(0)
    v_readfirstlane_b32 s20, v5
    s_cmp_lt_u32 s20, 1
    s_cbranch_scc1 k1_kernel_poll_43
k1_kernel_ok_42:
    ds_read_b128 v[80:83], v120 offset:0
    ds_read_b64_tr_b16 v[84:85], v124 offset:0
    ds_read_b64_tr_b16 v[86:87], v124 offset:768
    ds_read_b64_tr_b16 v[88:89], v124 offset:64
    ds_read_b64_tr_b16 v[90:91], v124 offset:832
    ds_read_b64_tr_b16 v[92:93], v124 offset:128
    ds_read_b64_tr_b16 v[94:95], v124 offset:896
    s_waitcnt lgkmcnt(14)
    v_mfma_f32_32x32x16_bf16 v[16:31], v[128:131], v[132:135], v[16:31]
    v_mfma_f32_32x32x16_bf16 v[32:47], v[128:131], v[136:139], v[32:47]
    v_mfma_f32_32x32x16_bf16 v[48:63], v[128:131], v[140:143], v[48:63]
    ds_read_b128 v[128:131], v121 offset:0
    ds_read_b64_tr_b16 v[132:133], v124 offset:3072
    ds_read_b64_tr_b16 v[134:135], v124 offset:3840
    ds_read_b64_tr_b16 v[136:137], v124 offset:3136
    ds_read_b64_tr_b16 v[138:139], v124 offset:3904
    ds_read_b64_tr_b16 v[140:141], v124 offset:3200
    ds_read_b64_tr_b16 v[142:143], v124 offset:3968
    s_waitcnt lgkmcnt(14)
    v_mfma_f32_32x32x16_bf16 v[16:31], v[64:67], v[68:71], v[16:31]
    v_mfma_f32_32x32x16_bf16 v[32:47], v[64:67], v[72:75], v[32:47]
    v_mfma_f32_32x32x16_bf16 v[48:63], v[64:67], v[76:79], v[48:63]
    ds_read_b32 v15, v14 offset:20
    ds_read_b128 v[64:67], v122 offset:0
    ds_read_b64_tr_b16 v[68:69], v124 offset:6144
    ds_read_b64_tr_b16 v[70:71], v124 offset:6912
    ds_read_b64_tr_b16 v[72:73], v124 offset:6208
    ds_read_b64_tr_b16 v[74:75], v124 offset:6976
    ds_read_b64_tr_b16 v[76:77], v124 offset:6272
    ds_read_b64_tr_b16 v[78:79], v124 offset:7040
    s_waitcnt lgkmcnt(15)
    v_mfma_f32_32x32x16_bf16 v[16:31], v[80:83], v[84:87], v[16:31]
    v_mfma_f32_32x32x16_bf16 v[32:47], v[80:83], v[88:91], v[32:47]
    v_mfma_f32_32x32x16_bf16 v[48:63], v[80:83], v[92:95], v[48:63]
    ds_read_b128 v[80:83], v123 offset:0
    ds_read_b64_tr_b16 v[84:85], v124 offset:9216
    ds_read_b64_tr_b16 v[86:87], v124 offset:9984
    ds_read_b64_tr_b16 v[88:89], v124 offset:9280
    ds_read_b64_tr_b16 v[90:91], v124 offset:10048
    ds_read_b64_tr_b16 v[92:93], v124 offset:9344
    ds_read_b64_tr_b16 v[94:95], v124 offset:10112
    s_waitcnt lgkmcnt(15)
    v_mfma_f32_32x32x16_bf16 v[16:31], v[128:131], v[132:135], v[16:31]
    v_mfma_f32_32x32x16_bf16 v[32:47], v[128:131], v[136:139], v[32:47]
    v_mfma_f32_32x32x16_bf16 v[48:63], v[128:131], v[140:143], v[48:63]
    s_waitcnt lgkmcnt(14)
    v_readfirstlane_b32 s35, v15
    s_cmp_ge_u32 s35, 1
    s_cbranch_scc1 k1_kernel_ok_44
k1_kernel_poll_45:
    ds_read_b32 v5, v14 offset:20
    s_waitcnt lgkmcnt(0)
    v_readfirstlane_b32 s20, v5
    s_cmp_lt_u32 s20, 1
    s_cbranch_scc1 k1_kernel_poll_45
k1_kernel_ok_44:
    ds_read_b128 v[128:131], v8 offset:0
    ds_read_b64_tr_b16 v[132:133], v12 offset:0
    ds_read_b64_tr_b16 v[134:135], v12 offset:768
    ds_read_b64_tr_b16 v[136:137], v12 offset:64
    ds_read_b64_tr_b16 v[138:139], v12 offset:832
    ds_read_b64_tr_b16 v[140:141], v12 offset:128
    ds_read_b64_tr_b16 v[142:143], v12 offset:896
    s_waitcnt lgkmcnt(14)
    v_mfma_f32_32x32x16_bf16 v[16:31], v[64:67], v[68:71], v[16:31]
    v_mfma_f32_32x32x16_bf16 v[32:47], v[64:67], v[72:75], v[32:47]
    v_mfma_f32_32x32x16_bf16 v[48:63], v[64:67], v[76:79], v[48:63]
    ds_read_b128 v[64:67], v9 offset:0
    ds_read_b64_tr_b16 v[68:69], v12 offset:3072
    ds_read_b64_tr_b16 v[70:71], v12 offset:3840
    ds_read_b64_tr_b16 v[72:73], v12 offset:3136
    ds_read_b64_tr_b16 v[74:75], v12 offset:3904
    ds_read_b64_tr_b16 v[76:77], v12 offset:3200
    ds_read_b64_tr_b16 v[78:79], v12 offset:3968
    s_waitcnt lgkmcnt(14)
    v_mfma_f32_32x32x16_bf16 v[16:31], v[80:83], v[84:87], v[16:31]
    v_mfma_f32_32x32x16_bf16 v[32:47], v[80:83], v[88:91], v[32:47]
    v_mfma_f32_32x32x16_bf16 v[48:63], v[80:83], v[92:95], v[48:63]
    ds_read_b32 v15, v14 offset:24
    ds_read_b128 v[80:83], v10 offset:0
    ds_read_b64_tr_b16 v[84:85], v12 offset:6144
    ds_read_b64_tr_b16 v[86:87], v12 offset:6912
    ds_read_b64_tr_b16 v[88:89], v12 offset:6208
    ds_read_b64_tr_b16 v[90:91], v12 offset:6976
    ds_read_b64_tr_b16 v[92:93], v12 offset:6272
    ds_read_b64_tr_b16 v[94:95], v12 offset:7040
    s_waitcnt lgkmcnt(15)
    v_mfma_f32_32x32x16_bf16 v[16:31], v[128:131], v[132:135], v[16:31]
    v_mfma_f32_32x32x16_bf16 v[32:47], v[128:131], v[136:139], v[32:47]
    v_mfma_f32_32x32x16_bf16 v[48:63], v[128:131], v[140:143], v[48:63]
    ds_read_b128 v[128:131], v11 offset:0
    ds_read_b64_tr_b16 v[132:133], v12 offset:9216
    ds_read_b64_tr_b16 v[134:135], v12 offset:9984
    ds_read_b64_tr_b16 v[136:137], v12 offset:9280
    ds_read_b64_tr_b16 v[138:139], v12 offset:10048
    ds_read_b64_tr_b16 v[140:141], v12 offset:9344
    ds_read_b64_tr_b16 v[142:143], v12 offset:10112
    s_waitcnt lgkmcnt(15)
    v_mfma_f32_32x32x16_bf16 v[16:31], v[64:67], v[68:71], v[16:31]
    v_mfma_f32_32x32x16_bf16 v[32:47], v[64:67], v[72:75], v[32:47]
    v_mfma_f32_32x32x16_bf16 v[48:63], v[64:67], v[76:79], v[48:63]
    s_waitcnt lgkmcnt(14)
    v_readfirstlane_b32 s35, v15
    s_cmp_ge_u32 s35, 1
    s_cbranch_scc1 k1_kernel_ok_46
k1_kernel_poll_47:
    ds_read_b32 v5, v14 offset:24
    s_waitcnt lgkmcnt(0)
    v_readfirstlane_b32 s20, v5
    s_cmp_lt_u32 s20, 1
    s_cbranch_scc1 k1_kernel_poll_47
k1_kernel_ok_46:
    ds_read_b128 v[64:67], v8 offset:28672
    ds_read_b64_tr_b16 v[68:69], v12 offset:28672
    ds_read_b64_tr_b16 v[70:71], v12 offset:29440
    ds_read_b64_tr_b16 v[72:73], v12 offset:28736
    ds_read_b64_tr_b16 v[74:75], v12 offset:29504
    ds_read_b64_tr_b16 v[76:77], v12 offset:28800
    ds_read_b64_tr_b16 v[78:79], v12 offset:29568
    s_waitcnt lgkmcnt(14)
    v_mfma_f32_32x32x16_bf16 v[16:31], v[80:83], v[84:87], v[16:31]
    v_mfma_f32_32x32x16_bf16 v[32:47], v[80:83], v[88:91], v[32:47]
    v_mfma_f32_32x32x16_bf16 v[48:63], v[80:83], v[92:95], v[48:63]
    ds_read_b128 v[80:83], v9 offset:28672
    ds_read_b64_tr_b16 v[84:85], v12 offset:31744
    ds_read_b64_tr_b16 v[86:87], v12 offset:32512
    ds_read_b64_tr_b16 v[88:89], v12 offset:31808
    ds_read_b64_tr_b16 v[90:91], v12 offset:32576
    ds_read_b64_tr_b16 v[92:93], v12 offset:31872
    ds_read_b64_tr_b16 v[94:95], v12 offset:32640
    s_waitcnt lgkmcnt(14)
    v_mfma_f32_32x32x16_bf16 v[16:31], v[128:131], v[132:135], v[16:31]
    v_mfma_f32_32x32x16_bf16 v[32:47], v[128:131], v[136:139], v[32:47]
    v_mfma_f32_32x32x16_bf16 v[48:63], v[128:131], v[140:143], v[48:63]
    ds_read_b128 v[128:131], v10 offset:28672
    ds_read_b64_tr_b16 v[132:133], v12 offset:34816
    ds_read_b64_tr_b16 v[134:135], v12 offset:35584
    ds_read_b64_tr_b16 v[136:137], v12 offset:34880
    ds_read_b64_tr_b16 v[138:139], v12 offset:35648
    ds_read_b64_tr_b16 v[140:141], v12 offset:34944
    ds_read_b64_tr_b16 v[142:143], v12 offset:35712
    s_waitcnt lgkmcnt(14)
    v_mfma_f32_32x32x16_bf16 v[16:31], v[64:67], v[68:71], v[16:31]
    v_mfma_f32_32x32x16_bf16 v[32:47], v[64:67], v[72:75], v[32:47]
    v_mfma_f32_32x32x16_bf16 v[48:63], v[64:67], v[76:79], v[48:63]
    ds_read_b128 v[64:67], v11 offset:28672
    ds_read_b64_tr_b16 v[68:69], v12 offset:37888
    ds_read_b64_tr_b16 v[70:71], v12 offset:38656
    ds_read_b64_tr_b16 v[72:73], v12 offset:37952
    ds_read_b64_tr_b16 v[74:75], v12 offset:38720
    ds_read_b64_tr_b16 v[76:77], v12 offset:38016
    ds_read_b64_tr_b16 v[78:79], v12 offset:38784
    s_waitcnt lgkmcnt(14)
    v_mfma_f32_32x32x16_bf16 v[16:31], v[80:83], v[84:87], v[16:31]
    v_mfma_f32_32x32x16_bf16 v[32:47], v[80:83], v[88:91], v[32:47]
    v_mfma_f32_32x32x16_bf16 v[48:63], v[80:83], v[92:95], v[48:63]
    s_waitcnt lgkmcnt(7)
    v_mfma_f32_32x32x16_bf16 v[16:31], v[128:131], v[132:135], v[16:31]
    v_mfma_f32_32x32x16_bf16 v[32:47], v[128:131], v[136:139], v[32:47]
    v_mfma_f32_32x32x16_bf16 v[48:63], v[128:131], v[140:143], v[48:63]
    s_waitcnt lgkmcnt(0)
    v_mfma_f32_32x32x16_bf16 v[16:31], v[64:67], v[68:71], v[16:31]
    v_mfma_f32_32x32x16_bf16 v[32:47], v[64:67], v[72:75], v[32:47]
    v_mfma_f32_32x32x16_bf16 v[48:63], v[64:67], v[76:79], v[48:63]
    s_mov_b64 exec, s[56:57]
    buffer_store_dwordx4 v[104:107], v102, s[16:19], s28 offen sc0 sc1
    s_mov_b64 exec, -1
    s_nop 6
    v_cvt_pk_bf16_f32 v64, v16, v17
    v_cvt_pk_bf16_f32 v65, v18, v19
    v_cvt_pk_bf16_f32 v66, v20, v21
    v_cvt_pk_bf16_f32 v67, v22, v23
    v_cvt_pk_bf16_f32 v68, v24, v25
    v_cvt_pk_bf16_f32 v69, v26, v27
    v_cvt_pk_bf16_f32 v70, v28, v29
    v_cvt_pk_bf16_f32 v71, v30, v31
    buffer_store_dwordx4 v[64:67], v96, s[16:19], s26 offen sc0 sc1
    buffer_store_dwordx4 v[68:71], v96, s[16:19], s26 offen offset:1024 sc0 sc1
    v_cvt_pk_bf16_f32 v76, v32, v33
    v_cvt_pk_bf16_f32 v77, v34, v35
    v_cvt_pk_bf16_f32 v78, v36, v37
    v_cvt_pk_bf16_f32 v79, v38, v39
    v_cvt_pk_bf16_f32 v80, v40, v41
    v_cvt_pk_bf16_f32 v81, v42, v43
    v_cvt_pk_bf16_f32 v82, v44, v45
    v_cvt_pk_bf16_f32 v83, v46, v47
    buffer_store_dwordx4 v[76:79], v98, s[16:19], s27 offen sc0 sc1
    buffer_store_dwordx4 v[80:83], v98, s[16:19], s27 offen offset:1024 sc0 sc1
    v_cvt_pk_bf16_f32 v88, v48, v49
    v_cvt_pk_bf16_f32 v89, v50, v51
    v_cvt_pk_bf16_f32 v90, v52, v53
    v_cvt_pk_bf16_f32 v91, v54, v55
    v_cvt_pk_bf16_f32 v92, v56, v57
    v_cvt_pk_bf16_f32 v93, v58, v59
    v_cvt_pk_bf16_f32 v94, v60, v61
    v_cvt_pk_bf16_f32 v95, v62, v63
    buffer_store_dwordx4 v[88:91], v100, s[16:19], s28 offen sc0 sc1
    buffer_store_dwordx4 v[92:95], v100, s[16:19], s28 offen offset:1024 sc0 sc1
    s_waitcnt vmcnt(0) lgkmcnt(0)
    s_branch k2_entry
k1_kgen:
    s_sub_u32 s3, s3, 4
    s_and_b32 s21, s3, 1
    s_lshl_b32 s22, s2, 1
    s_add_u32 s22, s22, s21
    s_lshr_b32 s23, s3, 1
    s_lshl_b32 s24, s22, 9
    s_lshl_b32 s20, s23, 8
    s_add_u32 s24, s24, s20
    v_add_u32 v1, s24, v1
    s_lshl_b32 s25, s2, 2
    s_lshl_b32 s26, s2, 2
    s_add_u32 s26, s26, s3
    s_mul_i32 s27, s26, 4682
    s_lshr_b32 s27, s27, 16
    s_mul_i32 s20, s27, 14
    s_sub_u32 s28, s26, s20
    s_lshl_b32 s29, s3, 12
    s_add_u32 s29, s29, 143616
    s_lshl_b32 s33, s3, 11
    s_add_u32 s33, s33, 57600
    s_waitcnt lgkmcnt(0)
    s_load_dword s62, s[56:57], s25
    s_load_dword s63, s[58:59], s25
    global_load_dword v2, v1, s[44:45]
    global_load_dword v3, v1, s[46:47]
    global_load_dword v4, v1, s[48:49]
    global_load_dword v5, v1, s[50:51]
    global_load_dword v6, v1, s[52:53]
    global_load_dword v7, v1, s[54:55]
    s_barrier
    s_mov_b32 s8, s42
    s_mov_b32 s9, s43
    s_mov_b32 s10, 1835008
    s_mov_b32 s11, 0x00020000
    s_mov_b32 s16, s60
    s_mov_b32 s17, s61
    s_mov_b32 s18, 14680064
    s_mov_b32 s19, 0x00020000
    v_lshrrev_b32 v8, 2, v0
    v_mul_u32_u24 v8, 896, v8
    v_and_b32 v9, 3, v0
    v_lshl_add_u32 v47, v9, 4, v8
    s_mul_i32 s34, s27, 28672
    s_lshl_b32 s20, s28, 6
    s_add_u32 s34, s34, s20
    v_and_b32 v8, 31, v0
    v_lshrrev_b32 v9, 5, v0
    v_and_b32 v10, 1, v0
    v_lshlrev_b32 v10, 4, v10
    v_mov_b32 v11, 0x3f80
    v_lshlrev_b32 v10, v10, v11
    v_lshrrev_b32 v8, 1, v8
    v_lshlrev_b32 v11, 2, v9
    v_sub_u32 v11, v8, v11
    v_subrev_u32 v12, 8, v11
    v_lshlrev_b32 v9, 5, v9
    v_sub_u32 v13, v8, v9
    v_subrev_u32 v13, 8, v13
    v_add_u32 v9, v8, v9
    v_subrev_u32 v9, 40, v9
    v_cmp_eq_u32 vcc, 0, v11
    s_nop 1
    v_cndmask_b32 v40, 0, v10, vcc
    v_cmp_eq_u32 vcc, 1, v11
    s_nop 1
    v_cndmask_b32 v41, 0, v10, vcc
    v_cmp_eq_u32 vcc, 2, v11
    s_nop 1
    v_cndmask_b32 v42, 0, v10, vcc
    v_cmp_eq_u32 vcc, 3, v11
    s_nop 1
    v_cndmask_b32 v43, 0, v10, vcc
    v_cmp_eq_u32 vcc, 0, v12
    s_nop 1
    v_cndmask_b32 v44, 0, v10, vcc
    v_cmp_eq_u32 vcc, 1, v12
    s_nop 1
    v_cndmask_b32 v45, 0, v10, vcc
    v_cmp_eq_u32 vcc, 2, v12
    s_nop 1
    v_cndmask_b32 v46, 0, v10, vcc
    v_cmp_eq_u32 vcc, 3, v12
    s_nop 1
    v_cndmask_b32 v47, 0, v10, vcc
    v_cmp_eq_u32 vcc, 0, v13
    s_nop 1
    v_cndmask_b32 v48, 0, v10, vcc
    v_cmp_eq_u32 vcc, 1, v13
    s_nop 1
    v_cndmask_b32 v49, 0, v10, vcc
    v_cmp_eq_u32 vcc, 2, v13
    s_nop 1
    v_cndmask_b32 v50, 0, v10, vcc
    v_cmp_eq_u32 vcc, 3, v13
    s_nop 1
    v_cndmask_b32 v51, 0, v10, vcc
    v_cmp_eq_u32 vcc, 0, v9
    s_nop 1
    v_cndmask_b32 v52, 0, v10, vcc
    v_cmp_eq_u32 vcc, 1, v9
    s_nop 1
    v_cndmask_b32 v53, 0, v10, vcc
    v_cmp_eq_u32 vcc, 2, v9
    s_nop 1
    v_cndmask_b32 v54, 0, v10, vcc
    v_cmp_eq_u32 vcc, 3, v9
    s_nop 1
    v_cndmask_b32 v55, 0, v10, vcc
    s_waitcnt lgkmcnt(0)
    s_lshl_b32 s21, s21, 4
    s_lshr_b32 s62, s62, s21
    s_lshl_b32 s62, s62, 16
    s_lshr_b32 s63, s63, s21
    s_lshl_b32 s63, s63, 16
    v_mov_b32 v20, 0x3fb8aa3b
    v_mul_f32 v20, s62, v20
    v_exp_f32 v20, v20
    s_nop 0
    v_cvt_pk_bf16_f32 v20, v20, v20
    v_and_b32 v20, 0xffff0000, v20
    s_nop 0
    v_readfirstlane_b32 s64, v20
    s_waitcnt vmcnt(0)
    v_lshlrev_b32 v20, 16, v2
    v_lshlrev_b32 v21, 16, v3
    v_lshlrev_b32 v22, 16, v4
    v_lshlrev_b32 v23, 16, v5
    v_lshlrev_b32 v24, 16, v6
    v_lshlrev_b32 v25, 16, v7
    v_mul_f32 v20, s64, v20
    v_mul_f32 v21, s64, v21
    v_mul_f32 v22, s64, v22
    v_mul_f32 v23, s64, v23
    v_mul_f32 v20, 0x3fb8aa3b, v20
    v_mul_f32 v21, 0x3e22f983, v21
    v_pk_mul_f32 v[14:15], v[24:25], v[22:23] op_sel:[0,0] op_sel_hi:[1,0]
    v_pk_fma_f32 v[14:15], v[24:25], v[22:23], v[14:15] op_sel:[1,1,0] op_sel_hi:[0,1,1] neg_lo:[1,0,0]
    v_mul_f32 v26, 0x41000000, v20
    v_mul_f32 v27, 0x41000000, v21
    v_exp_f32 v26, v26
    v_fract_f32 v27, v27
    v_cos_f32 v10, v27
    v_sin_f32 v11, v27
    v_mul_f32 v10, v26, v10
    v_mul_f32 v11, v26, v11
    v_exp_f32 v26, v20
    v_fract_f32 v27, v21
    v_cos_f32 v8, v27
    v_sin_f32 v9, v27
    v_mul_f32 v8, v26, v8
    v_mul_f32 v9, v26, v9
    v_mul_f32 v26, 0x43800000, v20
    v_mul_f32 v27, 0x43800000, v21
    v_exp_f32 v26, v26
    v_fract_f32 v27, v27
    v_cos_f32 v12, v27
    v_sin_f32 v13, v27
    v_mul_f32 v12, v26, v12
    v_mul_f32 v13, v26, v13
    v_cvt_pk_bf16_f32 v56, 1.0, v10
    v_cvt_pk_bf16_f32 v64, 0, v11
    v_pk_mul_f32 v[32:33], v[10:11], v[10:11] op_sel:[0,0] op_sel_hi:[1,0]
    v_pk_fma_f32 v[32:33], v[10:11], v[10:11], v[32:33] op_sel:[1,1,0] op_sel_hi:[0,1,1] neg_lo:[1,0,0]
    v_pk_mul_f32 v[34:35], v[32:33], v[10:11] op_sel:[0,0] op_sel_hi:[1,0]
    v_pk_fma_f32 v[34:35], v[32:33], v[10:11], v[34:35] op_sel:[1,1,0] op_sel_hi:[0,1,1] neg_lo:[1,0,0]
    v_cvt_pk_bf16_f32 v57, v32, v34
    v_cvt_pk_bf16_f32 v65, v33, v35
    v_pk_mul_f32 v[28:29], v[34:35], v[10:11] op_sel:[0,0] op_sel_hi:[1,0]
    v_pk_fma_f32 v[28:29], v[34:35], v[10:11], v[28:29] op_sel:[1,1,0] op_sel_hi:[0,1,1] neg_lo:[1,0,0]
    v_pk_mul_f32 v[30:31], v[28:29], v[10:11] op_sel:[0,0] op_sel_hi:[1,0]
    v_pk_fma_f32 v[30:31], v[28:29], v[10:11], v[30:31] op_sel:[1,1,0] op_sel_hi:[0,1,1] neg_lo:[1,0,0]
    v_cvt_pk_bf16_f32 v58, v28, v30
    v_cvt_pk_bf16_f32 v66, v29, v31
    v_pk_mul_f32 v[32:33], v[30:31], v[10:11] op_sel:[0,0] op_sel_hi:[1,0]
    v_pk_fma_f32 v[32:33], v[30:31], v[10:11], v[32:33] op_sel:[1,1,0] op_sel_hi:[0,1,1] neg_lo:[1,0,0]
    v_pk_mul_f32 v[34:35], v[32:33], v[10:11] op_sel:[0,0] op_sel_hi:[1,0]
    v_pk_fma_f32 v[34:35], v[32:33], v[10:11], v[34:35] op_sel:[1,1,0] op_sel_hi:[0,1,1] neg_lo:[1,0,0]
    v_cvt_pk_bf16_f32 v59, v32, v34
    v_cvt_pk_bf16_f32 v67, v33, v35
    v_pk_mul_f32 v[28:29], v[34:35], v[10:11] op_sel:[0,0] op_sel_hi:[1,0]
    v_pk_fma_f32 v[28:29], v[34:35], v[10:11], v[28:29] op_sel:[1,1,0] op_sel_hi:[0,1,1] neg_lo:[1,0,0]
    v_pk_mul_f32 v[30:31], v[28:29], v[10:11] op_sel:[0,0] op_sel_hi:[1,0]
    v_pk_fma_f32 v[30:31], v[28:29], v[10:11], v[30:31] op_sel:[1,1,0] op_sel_hi:[0,1,1] neg_lo:[1,0,0]
    v_cvt_pk_bf16_f32 v60, v28, v30
    v_cvt_pk_bf16_f32 v68, v29, v31
    v_pk_mul_f32 v[32:33], v[30:31], v[10:11] op_sel:[0,0] op_sel_hi:[1,0]
    v_pk_fma_f32 v[32:33], v[30:31], v[10:11], v[32:33] op_sel:[1,1,0] op_sel_hi:[0,1,1] neg_lo:[1,0,0]
    v_pk_mul_f32 v[34:35], v[32:33], v[10:11] op_sel:[0,0] op_sel_hi:[1,0]
    v_pk_fma_f32 v[34:35], v[32:33], v[10:11], v[34:35] op_sel:[1,1,0] op_sel_hi:[0,1,1] neg_lo:[1,0,0]
    v_cvt_pk_bf16_f32 v61, v32, v34
    v_cvt_pk_bf16_f32 v69, v33, v35
    v_pk_mul_f32 v[28:29], v[34:35], v[10:11] op_sel:[0,0] op_sel_hi:[1,0]
    v_pk_fma_f32 v[28:29], v[34:35], v[10:11], v[28:29] op_sel:[1,1,0] op_sel_hi:[0,1,1] neg_lo:[1,0,0]
    v_pk_mul_f32 v[30:31], v[28:29], v[10:11] op_sel:[0,0] op_sel_hi:[1,0]
    v_pk_fma_f32 v[30:31], v[28:29], v[10:11], v[30:31] op_sel:[1,1,0] op_sel_hi:[0,1,1] neg_lo:[1,0,0]
    v_cvt_pk_bf16_f32 v62, v28, v30
    v_cvt_pk_bf16_f32 v70, v29, v31
    v_pk_mul_f32 v[32:33], v[30:31], v[10:11] op_sel:[0,0] op_sel_hi:[1,0]
    v_pk_fma_f32 v[32:33], v[30:31], v[10:11], v[32:33] op_sel:[1,1,0] op_sel_hi:[0,1,1] neg_lo:[1,0,0]
    v_pk_mul_f32 v[34:35], v[32:33], v[10:11] op_sel:[0,0] op_sel_hi:[1,0]
    v_pk_fma_f32 v[34:35], v[32:33], v[10:11], v[34:35] op_sel:[1,1,0] op_sel_hi:[0,1,1] neg_lo:[1,0,0]
    v_cvt_pk_bf16_f32 v63, v32, v34
    v_cvt_pk_bf16_f32 v71, v33, v35
    v_permlane32_swap_b32 v56, v60
    v_permlane32_swap_b32 v57, v61
    v_permlane32_swap_b32 v58, v62
    v_permlane32_swap_b32 v59, v63
    v_permlane32_swap_b32 v64, v68
    v_permlane32_swap_b32 v65, v69
    v_permlane32_swap_b32 v66, v70
    v_permlane32_swap_b32 v67, v71
    v_mfma_f32_32x32x16_bf16 v[88:103], v[56:59], v[40:43], 0
    v_pk_mul_f32 v[28:29], v[34:35], v[10:11] op_sel:[0,0] op_sel_hi:[1,0]
    v_pk_fma_f32 v[28:29], v[34:35], v[10:11], v[28:29] op_sel:[1,1,0] op_sel_hi:[0,1,1] neg_lo:[1,0,0]
    v_pk_mul_f32 v[30:31], v[28:29], v[10:11] op_sel:[0,0] op_sel_hi:[1,0]
    v_pk_fma_f32 v[30:31], v[28:29], v[10:11], v[30:31] op_sel:[1,1,0] op_sel_hi:[0,1,1] neg_lo:[1,0,0]
    v_cvt_pk_bf16_f32 v72, v28, v30
    v_cvt_pk_bf16_f32 v80, v29, v31
    v_pk_mul_f32 v[32:33], v[30:31], v[10:11] op_sel:[0,0] op_sel_hi:[1,0]
    v_pk_fma_f32 v[32:33], v[30:31], v[10:11], v[32:33] op_sel:[1,1,0] op_sel_hi:[0,1,1] neg_lo:[1,0,0]
    v_pk_mul_f32 v[34:35], v[32:33], v[10:11] op_sel:[0,0] op_sel_hi:[1,0]
    v_pk_fma_f32 v[34:35], v[32:33], v[10:11], v[34:35] op_sel:[1,1,0] op_sel_hi:[0,1,1] neg_lo:[1,0,0]
    v_cvt_pk_bf16_f32 v73, v32, v34
    v_cvt_pk_bf16_f32 v81, v33, v35
    v_mfma_f32_32x32x16_bf16 v[104:119], v[60:63], v[40:43], 0
    v_pk_mul_f32 v[28:29], v[34:35], v[10:11] op_sel:[0,0] op_sel_hi:[1,0]
    v_pk_fma_f32 v[28:29], v[34:35], v[10:11], v[28:29] op_sel:[1,1,0] op_sel_hi:[0,1,1] neg_lo:[1,0,0]
    v_pk_mul_f32 v[30:31], v[28:29], v[10:11] op_sel:[0,0] op_sel_hi:[1,0]
    v_pk_fma_f32 v[30:31], v[28:29], v[10:11], v[30:31] op_sel:[1,1,0] op_sel_hi:[0,1,1] neg_lo:[1,0,0]
    v_cvt_pk_bf16_f32 v74, v28, v30
    v_cvt_pk_bf16_f32 v82, v29, v31
    v_pk_mul_f32 v[32:33], v[30:31], v[10:11] op_sel:[0,0] op_sel_hi:[1,0]
    v_pk_fma_f32 v[32:33], v[30:31], v[10:11], v[32:33] op_sel:[1,1,0] op_sel_hi:[0,1,1] neg_lo:[1,0,0]
    v_pk_mul_f32 v[34:35], v[32:33], v[10:11] op_sel:[0,0] op_sel_hi:[1,0]
    v_pk_fma_f32 v[34:35], v[32:33], v[10:11], v[34:35] op_sel:[1,1,0] op_sel_hi:[0,1,1] neg_lo:[1,0,0]
    v_cvt_pk_bf16_f32 v75, v32, v34
    v_cvt_pk_bf16_f32 v83, v33, v35
    v_mfma_f32_32x32x16_bf16 v[120:135], v[64:67], v[40:43], 0
    v_pk_mul_f32 v[28:29], v[34:35], v[10:11] op_sel:[0,0] op_sel_hi:[1,0]
    v_pk_fma_f32 v[28:29], v[34:35], v[10:11], v[28:29] op_sel:[1,1,0] op_sel_hi:[0,1,1] neg_lo:[1,0,0]
    v_pk_mul_f32 v[30:31], v[28:29], v[10:11] op_sel:[0,0] op_sel_hi:[1,0]
    v_pk_fma_f32 v[30:31], v[28:29], v[10:11], v[30:31] op_sel:[1,1,0] op_sel_hi:[0,1,1] neg_lo:[1,0,0]
    v_cvt_pk_bf16_f32 v76, v28, v30
    v_cvt_pk_bf16_f32 v84, v29, v31
    v_pk_mul_f32 v[32:33], v[30:31], v[10:11] op_sel:[0,0] op_sel_hi:[1,0]
    v_pk_fma_f32 v[32:33], v[30:31], v[10:11], v[32:33] op_sel:[1,1,0] op_sel_hi:[0,1,1] neg_lo:[1,0,0]
    v_pk_mul_f32 v[34:35], v[32:33], v[10:11] op_sel:[0,0] op_sel_hi:[1,0]
    v_pk_fma_f32 v[34:35], v[32:33], v[10:11], v[34:35] op_sel:[1,1,0] op_sel_hi:[0,1,1] neg_lo:[1,0,0]
    v_cvt_pk_bf16_f32 v77, v32, v34
    v_cvt_pk_bf16_f32 v85, v33, v35
    v_mfma_f32_32x32x16_bf16 v[136:151], v[68:71], v[40:43], 0
    v_pk_mul_f32 v[28:29], v[34:35], v[10:11] op_sel:[0,0] op_sel_hi:[1,0]
    v_pk_fma_f32 v[28:29], v[34:35], v[10:11], v[28:29] op_sel:[1,1,0] op_sel_hi:[0,1,1] neg_lo:[1,0,0]
    v_pk_mul_f32 v[30:31], v[28:29], v[10:11] op_sel:[0,0] op_sel_hi:[1,0]
    v_pk_fma_f32 v[30:31], v[28:29], v[10:11], v[30:31] op_sel:[1,1,0] op_sel_hi:[0,1,1] neg_lo:[1,0,0]
    v_cvt_pk_bf16_f32 v78, v28, v30
    v_cvt_pk_bf16_f32 v86, v29, v31
    v_pk_mul_f32 v[32:33], v[30:31], v[10:11] op_sel:[0,0] op_sel_hi:[1,0]
    v_pk_fma_f32 v[32:33], v[30:31], v[10:11], v[32:33] op_sel:[1,1,0] op_sel_hi:[0,1,1] neg_lo:[1,0,0]
    v_pk_mul_f32 v[34:35], v[32:33], v[10:11] op_sel:[0,0] op_sel_hi:[1,0]
    v_pk_fma_f32 v[34:35], v[32:33], v[10:11], v[34:35] op_sel:[1,1,0] op_sel_hi:[0,1,1] neg_lo:[1,0,0]
    v_cvt_pk_bf16_f32 v79, v32, v34
    v_cvt_pk_bf16_f32 v87, v33, v35
    v_permlane32_swap_b32 v72, v76
    v_permlane32_swap_b32 v73, v77
    v_permlane32_swap_b32 v74, v78
    v_permlane32_swap_b32 v75, v79
    v_permlane32_swap_b32 v80, v84
    v_permlane32_swap_b32 v81, v85
    v_permlane32_swap_b32 v82, v86
    v_permlane32_swap_b32 v83, v87
    v_mfma_f32_32x32x16_bf16 v[88:103], v[72:75], v[44:47], v[88:103]
    v_pk_mul_f32 v[28:29], v[14:15], v[8:9] op_sel:[0,0] op_sel_hi:[1,0]
    v_pk_fma_f32 v[28:29], v[14:15], v[8:9], v[28:29] op_sel:[1,1,0] op_sel_hi:[0,1,1] neg_lo:[1,0,0]
    v_pk_mul_f32 v[16:17], v[8:9], v[8:9] op_sel:[0,0] op_sel_hi:[1,0]
    v_pk_fma_f32 v[16:17], v[8:9], v[8:9], v[16:17] op_sel:[1,1,0] op_sel_hi:[0,1,1] neg_lo:[1,0,0]
    v_cvt_pk_bf16_f32 v56, v14, v28
    v_cvt_pk_bf16_f32 v64, -v15, -v29
    v_pk_mul_f32 v[30:31], v[28:29], v[8:9] op_sel:[0,0] op_sel_hi:[1,0]
    v_pk_fma_f32 v[30:31], v[28:29], v[8:9], v[30:31] op_sel:[1,1,0] op_sel_hi:[0,1,1] neg_lo:[1,0,0]
    v_mfma_f32_32x32x16_bf16 v[104:119], v[76:79], v[44:47], v[104:119]
    v_pk_mul_f32 v[36:37], v[14:15], v[12:13] op_sel:[0,0] op_sel_hi:[1,0]
    v_pk_fma_f32 v[36:37], v[14:15], v[12:13], v[36:37] op_sel:[1,1,0] op_sel_hi:[0,1,1] neg_lo:[1,0,0]
    v_pk_mul_f32 v[32:33], v[30:31], v[8:9] op_sel:[0,0] op_sel_hi:[1,0]
    v_pk_fma_f32 v[32:33], v[30:31], v[8:9], v[32:33] op_sel:[1,1,0] op_sel_hi:[0,1,1] neg_lo:[1,0,0]
    v_pk_mul_f32 v[18:19], v[16:17], v[16:17] op_sel:[0,0] op_sel_hi:[1,0]
    v_pk_fma_f32 v[18:19], v[16:17], v[16:17], v[18:19] op_sel:[1,1,0] op_sel_hi:[0,1,1] neg_lo:[1,0,0]
    v_cvt_pk_bf16_f32 v57, v30, v32
    v_cvt_pk_bf16_f32 v65, -v31, -v33
    v_mfma_f32_32x32x16_bf16 v[120:135], v[80:83], v[44:47], v[120:135]
    v_pk_mul_f32 v[34:35], v[32:33], v[8:9] op_sel:[0,0] op_sel_hi:[1,0]
    v_pk_fma_f32 v[34:35], v[32:33], v[8:9], v[34:35] op_sel:[1,1,0] op_sel_hi:[0,1,1] neg_lo:[1,0,0]
    v_pk_mul_f32 v[28:29], v[34:35], v[8:9] op_sel:[0,0] op_sel_hi:[1,0]
    v_pk_fma_f32 v[28:29], v[34:35], v[8:9], v[28:29] op_sel:[1,1,0] op_sel_hi:[0,1,1] neg_lo:[1,0,0]
    v_cvt_pk_bf16_f32 v58, v34, v28
    v_cvt_pk_bf16_f32 v66, -v35, -v29
    v_pk_mul_f32 v[30:31], v[28:29], v[8:9] op_sel:[0,0] op_sel_hi:[1,0]
    v_pk_fma_f32 v[30:31], v[28:29], v[8:9], v[30:31] op_sel:[1,1,0] op_sel_hi:[0,1,1] neg_lo:[1,0,0]
    v_mfma_f32_32x32x16_bf16 v[136:151], v[84:87], v[44:47], v[136:151]
    v_pk_mul_f32 v[32:33], v[30:31], v[8:9] op_sel:[0,0] op_sel_hi:[1,0]
    v_pk_fma_f32 v[32:33], v[30:31], v[8:9], v[32:33] op_sel:[1,1,0] op_sel_hi:[0,1,1] neg_lo:[1,0,0]
    v_cvt_pk_bf16_f32 v59, v30, v32
    v_cvt_pk_bf16_f32 v67, -v31, -v33
    v_pk_mul_f32 v[28:29], v[36:37], v[16:17] op_sel:[0,0] op_sel_hi:[1,0]
    v_pk_fma_f32 v[28:29], v[36:37], v[16:17], v[28:29] op_sel:[1,1,0] op_sel_hi:[0,1,1] neg_lo:[1,0,0]
    v_cvt_pk_bf16_f32 v60, v36, v28
    v_cvt_pk_bf16_f32 v68, -v37, -v29
    v_pk_mul_f32 v[30:31], v[28:29], v[16:17] op_sel:[0,0] op_sel_hi:[1,0]
    v_pk_fma_f32 v[30:31], v[28:29], v[16:17], v[30:31] op_sel:[1,1,0] op_sel_hi:[0,1,1] neg_lo:[1,0,0]
    v_pk_mul_f32 v[34:35], v[36:37], v[12:13] op_sel:[0,0] op_sel_hi:[1,0]
    v_pk_fma_f32 v[34:35], v[36:37], v[12:13], v[34:35] op_sel:[1,1,0] op_sel_hi:[0,1,1] neg_lo:[1,0,0]
    v_pk_mul_f32 v[32:33], v[30:31], v[16:17] op_sel:[0,0] op_sel_hi:[1,0]
    v_pk_fma_f32 v[32:33], v[30:31], v[16:17], v[32:33] op_sel:[1,1,0] op_sel_hi:[0,1,1] neg_lo:[1,0,0]
    v_cvt_pk_bf16_f32 v61, v30, v32
    v_cvt_pk_bf16_f32 v69, -v31, -v33
    v_pk_mul_f32 v[28:29], v[34:35], v[18:19] op_sel:[0,0] op_sel_hi:[1,0]
    v_pk_fma_f32 v[28:29], v[34:35], v[18:19], v[28:29] op_sel:[1,1,0] op_sel_hi:[0,1,1] neg_lo:[1,0,0]
    v_pk_mul_f32 v[36:37], v[34:35], v[12:13] op_sel:[0,0] op_sel_hi:[1,0]
    v_pk_fma_f32 v[36:37], v[34:35], v[12:13], v[36:37] op_sel:[1,1,0] op_sel_hi:[0,1,1] neg_lo:[1,0,0]
    v_cvt_pk_bf16_f32 v62, v34, v28
    v_cvt_pk_bf16_f32 v70, -v35, -v29
    v_pk_mul_f32 v[28:29], v[36:37], v[18:19] op_sel:[0,0] op_sel_hi:[1,0]
    v_pk_fma_f32 v[28:29], v[36:37], v[18:19], v[28:29] op_sel:[1,1,0] op_sel_hi:[0,1,1] neg_lo:[1,0,0]
    v_cvt_pk_bf16_f32 v63, v36, v28
    v_cvt_pk_bf16_f32 v71, -v37, -v29
    v_permlane32_swap_b32 v56, v60
    v_permlane32_swap_b32 v57, v61
    v_permlane32_swap_b32 v58, v62
    v_permlane32_swap_b32 v59, v63
    v_permlane32_swap_b32 v64, v68
    v_permlane32_swap_b32 v65, v69
    v_permlane32_swap_b32 v66, v70
    v_permlane32_swap_b32 v67, v71
    v_pk_mul_f32 v[30:31], v[36:37], v[12:13] op_sel:[0,0] op_sel_hi:[1,0]
    v_pk_fma_f32 v[30:31], v[36:37], v[12:13], v[30:31] op_sel:[1,1,0] op_sel_hi:[0,1,1] neg_lo:[1,0,0]
    v_pk_mul_f32 v[32:33], v[30:31], v[12:13] op_sel:[0,0] op_sel_hi:[1,0]
    v_pk_fma_f32 v[32:33], v[30:31], v[12:13], v[32:33] op_sel:[1,1,0] op_sel_hi:[0,1,1] neg_lo:[1,0,0]
    v_cvt_pk_bf16_f32 v72, v30, v32
    v_cvt_pk_bf16_f32 v80, -v31, -v33
    v_pk_mul_f32 v[34:35], v[32:33], v[12:13] op_sel:[0,0] op_sel_hi:[1,0]
    v_pk_fma_f32 v[34:35], v[32:33], v[12:13], v[34:35] op_sel:[1,1,0] op_sel_hi:[0,1,1] neg_lo:[1,0,0]
    v_pk_mul_f32 v[28:29], v[34:35], v[12:13] op_sel:[0,0] op_sel_hi:[1,0]
    v_pk_fma_f32 v[28:29], v[34:35], v[12:13], v[28:29] op_sel:[1,1,0] op_sel_hi:[0,1,1] neg_lo:[1,0,0]
    v_cvt_pk_bf16_f32 v73, v34, v28
    v_cvt_pk_bf16_f32 v81, -v35, -v29
    v_pk_mul_f32 v[30:31], v[28:29], v[12:13] op_sel:[0,0] op_sel_hi:[1,0]
    v_pk_fma_f32 v[30:31], v[28:29], v[12:13], v[30:31] op_sel:[1,1,0] op_sel_hi:[0,1,1] neg_lo:[1,0,0]
    v_cvt_pk_bf16_f32 v74, v30, v30
    v_cvt_pk_bf16_f32 v82, -v31, -v31
    v_cvt_pk_bf16_f32 v88, v88, v89
    v_cvt_pk_bf16_f32 v89, v90, v91
    v_cvt_pk_bf16_f32 v90, v92, v93
    v_cvt_pk_bf16_f32 v91, v94, v95
    v_cvt_pk_bf16_f32 v92, v96, v97
    v_cvt_pk_bf16_f32 v93, v98, v99
    v_cvt_pk_bf16_f32 v94, v100, v101
    v_cvt_pk_bf16_f32 v95, v102, v103
    v_cvt_pk_bf16_f32 v96, v104, v105
    v_cvt_pk_bf16_f32 v97, v106, v107
    v_cvt_pk_bf16_f32 v98, v108, v109
    v_cvt_pk_bf16_f32 v99, v110, v111
    v_cvt_pk_bf16_f32 v100, v112, v113
    v_cvt_pk_bf16_f32 v101, v114, v115
    v_cvt_pk_bf16_f32 v102, v116, v117
    v_cvt_pk_bf16_f32 v103, v118, v119
    v_mfma_f32_32x32x16_bf16 v[104:119], v[56:59], v[40:43], 0
    v_cvt_pk_bf16_f32 v120, v120, v121
    v_cvt_pk_bf16_f32 v121, v122, v123
    v_cvt_pk_bf16_f32 v122, v124, v125
    v_cvt_pk_bf16_f32 v123, v126, v127
    v_cvt_pk_bf16_f32 v124, v128, v129
    v_cvt_pk_bf16_f32 v125, v130, v131
    v_cvt_pk_bf16_f32 v126, v132, v133
    v_cvt_pk_bf16_f32 v127, v134, v135
    v_mfma_f32_32x32x16_bf16 v[104:119], v[72:75], v[48:51], v[104:119]
    v_cvt_pk_bf16_f32 v128, v136, v137
    v_cvt_pk_bf16_f32 v129, v138, v139
    v_cvt_pk_bf16_f32 v130, v140, v141
    v_cvt_pk_bf16_f32 v131, v142, v143
    v_cvt_pk_bf16_f32 v132, v144, v145
    v_cvt_pk_bf16_f32 v133, v146, v147
    v_cvt_pk_bf16_f32 v134, v148, v149
    v_cvt_pk_bf16_f32 v135, v150, v151
    v_mfma_f32_32x32x16_bf16 v[136:151], v[60:63], v[40:43], 0
    v_and_b32 v20, 0xffff0000, v2
    v_and_b32 v21, 0xffff0000, v3
    v_and_b32 v22, 0xffff0000, v4
    v_and_b32 v23, 0xffff0000, v5
    v_and_b32 v24, 0xffff0000, v6
    v_and_b32 v25, 0xffff0000, v7
    v_mul_f32 v20, s64, v20
    v_mul_f32 v21, s64, v21
    v_mfma_f32_32x32x16_bf16 v[136:151], v[72:75], v[52:55], v[136:151]
    v_mul_f32 v22, s64, v22
    v_mul_f32 v23, s64, v23
    v_mul_f32 v20, 0x3fb8aa3b, v20
    v_mul_f32 v21, 0x3e22f983, v21
    v_pk_mul_f32 v[14:15], v[24:25], v[22:23] op_sel:[0,0] op_sel_hi:[1,0]
    v_pk_fma_f32 v[14:15], v[24:25], v[22:23], v[14:15] op_sel:[1,1,0] op_sel_hi:[0,1,1] neg_lo:[1,0,0]
    v_mul_f32 v26, 0x41000000, v20
    v_mul_f32 v27, 0x41000000, v21
    v_exp_f32 v26, v26
    v_fract_f32 v27, v27
    v_cos_f32 v10, v27
    v_sin_f32 v11, v27
    v_mul_f32 v10, v26, v10
    v_mul_f32 v11, v26, v11
    v_exp_f32 v26, v20
    v_fract_f32 v27, v21
    v_cos_f32 v8, v27
    v_sin_f32 v9, v27
    v_mul_f32 v8, v26, v8
    v_mul_f32 v9, v26, v9
    v_mul_f32 v26, 0x43800000, v20
    v_mul_f32 v27, 0x43800000, v21
    v_exp_f32 v26, v26
    v_fract_f32 v27, v27
    v_cos_f32 v12, v27
    v_sin_f32 v13, v27
    v_mul_f32 v12, v26, v12
    v_mul_f32 v13, v26, v13
    v_cvt_pk_bf16_f32 v104, v104, v105
    v_cvt_pk_bf16_f32 v105, v106, v107
    v_cvt_pk_bf16_f32 v106, v108, v109
    v_cvt_pk_bf16_f32 v107, v110, v111
    v_cvt_pk_bf16_f32 v108, v112, v113
    v_cvt_pk_bf16_f32 v109, v114, v115
    v_cvt_pk_bf16_f32 v110, v116, v117
    v_cvt_pk_bf16_f32 v111, v118, v119
    v_mfma_f32_32x32x16_bf16 v[152:167], v[104:107], v[88:91], 0
    v_cvt_pk_bf16_f32 v136, v136, v137
    v_cvt_pk_bf16_f32 v137, v138, v139
    v_cvt_pk_bf16_f32 v138, v140, v141
    v_cvt_pk_bf16_f32 v139, v142, v143
    v_cvt_pk_bf16_f32 v140, v144, v145
    v_cvt_pk_bf16_f32 v141, v146, v147
    v_cvt_pk_bf16_f32 v142, v148, v149
    v_cvt_pk_bf16_f32 v143, v150, v151
    v_mfma_f32_32x32x16_bf16 v[152:167], v[108:111], v[92:95], v[152:167]
    v_cvt_pk_bf16_f32 v56, 1.0, v10
    v_cvt_pk_bf16_f32 v72, 0, v11
    v_pk_mul_f32 v[32:33], v[10:11], v[10:11] op_sel:[0,0] op_sel_hi:[1,0]
    v_pk_fma_f32 v[32:33], v[10:11], v[10:11], v[32:33] op_sel:[1,1,0] op_sel_hi:[0,1,1] neg_lo:[1,0,0]
    v_pk_mul_f32 v[34:35], v[32:33], v[10:11] op_sel:[0,0] op_sel_hi:[1,0]
    v_pk_fma_f32 v[34:35], v[32:33], v[10:11], v[34:35] op_sel:[1,1,0] op_sel_hi:[0,1,1] neg_lo:[1,0,0]
    v_mfma_f32_32x32x16_bf16 v[104:119], v[64:67], v[40:43], 0
    v_cvt_pk_bf16_f32 v57, v32, v34
    v_cvt_pk_bf16_f32 v73, v33, v35
    v_pk_mul_f32 v[28:29], v[34:35], v[10:11] op_sel:[0,0] op_sel_hi:[1,0]
    v_pk_fma_f32 v[28:29], v[34:35], v[10:11], v[28:29] op_sel:[1,1,0] op_sel_hi:[0,1,1] neg_lo:[1,0,0]
    v_pk_mul_f32 v[30:31], v[28:29], v[10:11] op_sel:[0,0] op_sel_hi:[1,0]
    v_pk_fma_f32 v[30:31], v[28:29], v[10:11], v[30:31] op_sel:[1,1,0] op_sel_hi:[0,1,1] neg_lo:[1,0,0]
    v_mfma_f32_32x32x16_bf16 v[104:119], v[80:83], v[48:51], v[104:119]
    v_cvt_pk_bf16_f32 v58, v28, v30
    v_cvt_pk_bf16_f32 v74, v29, v31
    v_pk_mul_f32 v[32:33], v[30:31], v[10:11] op_sel:[0,0] op_sel_hi:[1,0]
    v_pk_fma_f32 v[32:33], v[30:31], v[10:11], v[32:33] op_sel:[1,1,0] op_sel_hi:[0,1,1] neg_lo:[1,0,0]
    v_pk_mul_f32 v[34:35], v[32:33], v[10:11] op_sel:[0,0] op_sel_hi:[1,0]
    v_pk_fma_f32 v[34:35], v[32:33], v[10:11], v[34:35] op_sel:[1,1,0] op_sel_hi:[0,1,1] neg_lo:[1,0,0]
    v_mfma_f32_32x32x16_bf16 v[152:167], v[136:139], v[96:99], v[152:167]
    v_cvt_pk_bf16_f32 v59, v32, v34
    v_cvt_pk_bf16_f32 v75, v33, v35
    v_pk_mul_f32 v[28:29], v[34:35], v[10:11] op_sel:[0,0] op_sel_hi:[1,0]
    v_pk_fma_f32 v[28:29], v[34:35], v[10:11], v[28:29] op_sel:[1,1,0] op_sel_hi:[0,1,1] neg_lo:[1,0,0]
    v_pk_mul_f32 v[30:31], v[28:29], v[10:11] op_sel:[0,0] op_sel_hi:[1,0]
    v_pk_fma_f32 v[30:31], v[28:29], v[10:11], v[30:31] op_sel:[1,1,0] op_sel_hi:[0,1,1] neg_lo:[1,0,0]
    v_mfma_f32_32x32x16_bf16 v[152:167], v[140:143], v[100:103], v[152:167]
    v_cvt_pk_bf16_f32 v60, v28, v30
    v_cvt_pk_bf16_f32 v76, v29, v31
    v_pk_mul_f32 v[32:33], v[30:31], v[10:11] op_sel:[0,0] op_sel_hi:[1,0]
    v_pk_fma_f32 v[32:33], v[30:31], v[10:11], v[32:33] op_sel:[1,1,0] op_sel_hi:[0,1,1] neg_lo:[1,0,0]
    v_pk_mul_f32 v[34:35], v[32:33], v[10:11] op_sel:[0,0] op_sel_hi:[1,0]
    v_pk_fma_f32 v[34:35], v[32:33], v[10:11], v[34:35] op_sel:[1,1,0] op_sel_hi:[0,1,1] neg_lo:[1,0,0]
    v_mfma_f32_32x32x16_bf16 v[136:151], v[68:71], v[40:43], 0
    v_cvt_pk_bf16_f32 v61, v32, v34
    v_cvt_pk_bf16_f32 v77, v33, v35
    v_pk_mul_f32 v[28:29], v[34:35], v[10:11] op_sel:[0,0] op_sel_hi:[1,0]
    v_pk_fma_f32 v[28:29], v[34:35], v[10:11], v[28:29] op_sel:[1,1,0] op_sel_hi:[0,1,1] neg_lo:[1,0,0]
    v_pk_mul_f32 v[30:31], v[28:29], v[10:11] op_sel:[0,0] op_sel_hi:[1,0]
    v_pk_fma_f32 v[30:31], v[28:29], v[10:11], v[30:31] op_sel:[1,1,0] op_sel_hi:[0,1,1] neg_lo:[1,0,0]
    v_mfma_f32_32x32x16_bf16 v[136:151], v[80:83], v[52:55], v[136:151]
    v_cvt_pk_bf16_f32 v62, v28, v30
    v_cvt_pk_bf16_f32 v78, v29, v31
    v_pk_mul_f32 v[32:33], v[30:31], v[10:11] op_sel:[0,0] op_sel_hi:[1,0]
    v_pk_fma_f32 v[32:33], v[30:31], v[10:11], v[32:33] op_sel:[1,1,0] op_sel_hi:[0,1,1] neg_lo:[1,0,0]
    v_pk_mul_f32 v[34:35], v[32:33], v[10:11] op_sel:[0,0] op_sel_hi:[1,0]
    v_pk_fma_f32 v[34:35], v[32:33], v[10:11], v[34:35] op_sel:[1,1,0] op_sel_hi:[0,1,1] neg_lo:[1,0,0]
    v_cvt_pk_bf16_f32 v63, v32, v34
    v_cvt_pk_bf16_f32 v79, v33, v35
    v_permlane32_swap_b32 v56, v60
    v_permlane32_swap_b32 v57, v61
    v_permlane32_swap_b32 v58, v62
    v_permlane32_swap_b32 v59, v63
    v_permlane32_swap_b32 v72, v76
    v_permlane32_swap_b32 v73, v77
    v_permlane32_swap_b32 v74, v78
    v_permlane32_swap_b32 v75, v79
    v_cvt_pk_bf16_f32 v104, v104, v105
    v_cvt_pk_bf16_f32 v105, v106, v107
    v_cvt_pk_bf16_f32 v106, v108, v109
    v_cvt_pk_bf16_f32 v107, v110, v111
    v_cvt_pk_bf16_f32 v108, v112, v113
    v_cvt_pk_bf16_f32 v109, v114, v115
    v_cvt_pk_bf16_f32 v110, v116, v117
    v_cvt_pk_bf16_f32 v111, v118, v119
    v_cvt_pk_bf16_f32 v136, v136, v137
    v_cvt_pk_bf16_f32 v137, v138, v139
    v_cvt_pk_bf16_f32 v138, v140, v141
    v_cvt_pk_bf16_f32 v139, v142, v143
    v_cvt_pk_bf16_f32 v140, v144, v145
    v_cvt_pk_bf16_f32 v141, v146, v147
    v_cvt_pk_bf16_f32 v142, v148, v149
    v_cvt_pk_bf16_f32 v143, v150, v151
    v_mfma_f32_32x32x16_bf16 v[152:167], v[104:107], v[120:123], v[152:167]
    v_pk_mul_f32 v[28:29], v[34:35], v[10:11] op_sel:[0,0] op_sel_hi:[1,0]
    v_pk_fma_f32 v[28:29], v[34:35], v[10:11], v[28:29] op_sel:[1,1,0] op_sel_hi:[0,1,1] neg_lo:[1,0,0]
    v_pk_mul_f32 v[30:31], v[28:29], v[10:11] op_sel:[0,0] op_sel_hi:[1,0]
    v_pk_fma_f32 v[30:31], v[28:29], v[10:11], v[30:31] op_sel:[1,1,0] op_sel_hi:[0,1,1] neg_lo:[1,0,0]
    v_cvt_pk_bf16_f32 v64, v28, v30
    v_cvt_pk_bf16_f32 v80, v29, v31
    v_mfma_f32_32x32x16_bf16 v[152:167], v[108:111], v[124:127], v[152:167]
    v_pk_mul_f32 v[32:33], v[30:31], v[10:11] op_sel:[0,0] op_sel_hi:[1,0]
    v_pk_fma_f32 v[32:33], v[30:31], v[10:11], v[32:33] op_sel:[1,1,0] op_sel_hi:[0,1,1] neg_lo:[1,0,0]
    v_pk_mul_f32 v[34:35], v[32:33], v[10:11] op_sel:[0,0] op_sel_hi:[1,0]
    v_pk_fma_f32 v[34:35], v[32:33], v[10:11], v[34:35] op_sel:[1,1,0] op_sel_hi:[0,1,1] neg_lo:[1,0,0]
    v_cvt_pk_bf16_f32 v65, v32, v34
    v_cvt_pk_bf16_f32 v81, v33, v35
    v_mfma_f32_32x32x16_bf16 v[152:167], v[136:139], v[128:131], v[152:167]
    v_pk_mul_f32 v[28:29], v[34:35], v[10:11] op_sel:[0,0] op_sel_hi:[1,0]
    v_pk_fma_f32 v[28:29], v[34:35], v[10:11], v[28:29] op_sel:[1,1,0] op_sel_hi:[0,1,1] neg_lo:[1,0,0]
    v_pk_mul_f32 v[30:31], v[28:29], v[10:11] op_sel:[0,0] op_sel_hi:[1,0]
    v_pk_fma_f32 v[30:31], v[28:29], v[10:11], v[30:31] op_sel:[1,1,0] op_sel_hi:[0,1,1] neg_lo:[1,0,0]
    v_cvt_pk_bf16_f32 v66, v28, v30
    v_cvt_pk_bf16_f32 v82, v29, v31
    v_mfma_f32_32x32x16_bf16 v[152:167], v[140:143], v[132:135], v[152:167]
    v_pk_mul_f32 v[32:33], v[30:31], v[10:11] op_sel:[0,0] op_sel_hi:[1,0]
    v_pk_fma_f32 v[32:33], v[30:31], v[10:11], v[32:33] op_sel:[1,1,0] op_sel_hi:[0,1,1] neg_lo:[1,0,0]
    v_pk_mul_f32 v[34:35], v[32:33], v[10:11] op_sel:[0,0] op_sel_hi:[1,0]
    v_pk_fma_f32 v[34:35], v[32:33], v[10:11], v[34:35] op_sel:[1,1,0] op_sel_hi:[0,1,1] neg_lo:[1,0,0]
    v_cvt_pk_bf16_f32 v67, v32, v34
    v_cvt_pk_bf16_f32 v83, v33, v35
    v_mfma_f32_32x32x16_bf16 v[88:103], v[56:59], v[40:43], 0
    v_pk_mul_f32 v[28:29], v[34:35], v[10:11] op_sel:[0,0] op_sel_hi:[1,0]
    v_pk_fma_f32 v[28:29], v[34:35], v[10:11], v[28:29] op_sel:[1,1,0] op_sel_hi:[0,1,1] neg_lo:[1,0,0]
    v_pk_mul_f32 v[30:31], v[28:29], v[10:11] op_sel:[0,0] op_sel_hi:[1,0]
    v_pk_fma_f32 v[30:31], v[28:29], v[10:11], v[30:31] op_sel:[1,1,0] op_sel_hi:[0,1,1] neg_lo:[1,0,0]
    v_cvt_pk_bf16_f32 v68, v28, v30
    v_cvt_pk_bf16_f32 v84, v29, v31
    v_mfma_f32_32x32x16_bf16 v[104:119], v[60:63], v[40:43], 0
    v_pk_mul_f32 v[32:33], v[30:31], v[10:11] op_sel:[0,0] op_sel_hi:[1,0]
    v_pk_fma_f32 v[32:33], v[30:31], v[10:11], v[32:33] op_sel:[1,1,0] op_sel_hi:[0,1,1] neg_lo:[1,0,0]
    v_pk_mul_f32 v[34:35], v[32:33], v[10:11] op_sel:[0,0] op_sel_hi:[1,0]
    v_pk_fma_f32 v[34:35], v[32:33], v[10:11], v[34:35] op_sel:[1,1,0] op_sel_hi:[0,1,1] neg_lo:[1,0,0]
    v_cvt_pk_bf16_f32 v69, v32, v34
    v_cvt_pk_bf16_f32 v85, v33, v35
    v_mfma_f32_32x32x16_bf16 v[120:135], v[72:75], v[40:43], 0
    v_pk_mul_f32 v[28:29], v[34:35], v[10:11] op_sel:[0,0] op_sel_hi:[1,0]
    v_pk_fma_f32 v[28:29], v[34:35], v[10:11], v[28:29] op_sel:[1,1,0] op_sel_hi:[0,1,1] neg_lo:[1,0,0]
    v_pk_mul_f32 v[30:31], v[28:29], v[10:11] op_sel:[0,0] op_sel_hi:[1,0]
    v_pk_fma_f32 v[30:31], v[28:29], v[10:11], v[30:31] op_sel:[1,1,0] op_sel_hi:[0,1,1] neg_lo:[1,0,0]
    v_cvt_pk_bf16_f32 v70, v28, v30
    v_cvt_pk_bf16_f32 v86, v29, v31
    v_mfma_f32_32x32x16_bf16 v[136:151], v[76:79], v[40:43], 0
    v_pk_mul_f32 v[32:33], v[30:31], v[10:11] op_sel:[0,0] op_sel_hi:[1,0]
    v_pk_fma_f32 v[32:33], v[30:31], v[10:11], v[32:33] op_sel:[1,1,0] op_sel_hi:[0,1,1] neg_lo:[1,0,0]
    v_pk_mul_f32 v[34:35], v[32:33], v[10:11] op_sel:[0,0] op_sel_hi:[1,0]
    v_pk_fma_f32 v[34:35], v[32:33], v[10:11], v[34:35] op_sel:[1,1,0] op_sel_hi:[0,1,1] neg_lo:[1,0,0]
    v_cvt_pk_bf16_f32 v71, v32, v34
    v_cvt_pk_bf16_f32 v87, v33, v35
    v_permlane32_swap_b32 v64, v68
    v_permlane32_swap_b32 v65, v69
    v_permlane32_swap_b32 v66, v70
    v_permlane32_swap_b32 v67, v71
    v_permlane32_swap_b32 v80, v84
    v_permlane32_swap_b32 v81, v85
    v_permlane32_swap_b32 v82, v86
    v_permlane32_swap_b32 v83, v87
    v_mfma_f32_32x32x16_bf16 v[88:103], v[64:67], v[44:47], v[88:103]
    v_pk_mul_f32 v[28:29], v[14:15], v[8:9] op_sel:[0,0] op_sel_hi:[1,0]
    v_pk_fma_f32 v[28:29], v[14:15], v[8:9], v[28:29] op_sel:[1,1,0] op_sel_hi:[0,1,1] neg_lo:[1,0,0]
    v_pk_mul_f32 v[16:17], v[8:9], v[8:9] op_sel:[0,0] op_sel_hi:[1,0]
    v_pk_fma_f32 v[16:17], v[8:9], v[8:9], v[16:17] op_sel:[1,1,0] op_sel_hi:[0,1,1] neg_lo:[1,0,0]
    v_cvt_pk_bf16_f32 v56, v14, v28
    v_cvt_pk_bf16_f32 v72, -v15, -v29
    v_pk_mul_f32 v[30:31], v[28:29], v[8:9] op_sel:[0,0] op_sel_hi:[1,0]
    v_pk_fma_f32 v[30:31], v[28:29], v[8:9], v[30:31] op_sel:[1,1,0] op_sel_hi:[0,1,1] neg_lo:[1,0,0]
    v_mfma_f32_32x32x16_bf16 v[104:119], v[68:71], v[44:47], v[104:119]
    v_pk_mul_f32 v[36:37], v[14:15], v[12:13] op_sel:[0,0] op_sel_hi:[1,0]
    v_pk_fma_f32 v[36:37], v[14:15], v[12:13], v[36:37] op_sel:[1,1,0] op_sel_hi:[0,1,1] neg_lo:[1,0,0]
    v_pk_mul_f32 v[32:33], v[30:31], v[8:9] op_sel:[0,0] op_sel_hi:[1,0]
    v_pk_fma_f32 v[32:33], v[30:31], v[8:9], v[32:33] op_sel:[1,1,0] op_sel_hi:[0,1,1] neg_lo:[1,0,0]
    v_pk_mul_f32 v[18:19], v[16:17], v[16:17] op_sel:[0,0] op_sel_hi:[1,0]
    v_pk_fma_f32 v[18:19], v[16:17], v[16:17], v[18:19] op_sel:[1,1,0] op_sel_hi:[0,1,1] neg_lo:[1,0,0]
    v_cvt_pk_bf16_f32 v57, v30, v32
    v_cvt_pk_bf16_f32 v73, -v31, -v33
    v_mfma_f32_32x32x16_bf16 v[120:135], v[80:83], v[44:47], v[120:135]
    v_pk_mul_f32 v[34:35], v[32:33], v[8:9] op_sel:[0,0] op_sel_hi:[1,0]
    v_pk_fma_f32 v[34:35], v[32:33], v[8:9], v[34:35] op_sel:[1,1,0] op_sel_hi:[0,1,1] neg_lo:[1,0,0]
    v_pk_mul_f32 v[28:29], v[34:35], v[8:9] op_sel:[0,0] op_sel_hi:[1,0]
    v_pk_fma_f32 v[28:29], v[34:35], v[8:9], v[28:29] op_sel:[1,1,0] op_sel_hi:[0,1,1] neg_lo:[1,0,0]
    v_cvt_pk_bf16_f32 v58, v34, v28
    v_cvt_pk_bf16_f32 v74, -v35, -v29
    v_pk_mul_f32 v[30:31], v[28:29], v[8:9] op_sel:[0,0] op_sel_hi:[1,0]
    v_pk_fma_f32 v[30:31], v[28:29], v[8:9], v[30:31] op_sel:[1,1,0] op_sel_hi:[0,1,1] neg_lo:[1,0,0]
    v_mfma_f32_32x32x16_bf16 v[136:151], v[84:87], v[44:47], v[136:151]
    v_pk_mul_f32 v[32:33], v[30:31], v[8:9] op_sel:[0,0] op_sel_hi:[1,0]
    v_pk_fma_f32 v[32:33], v[30:31], v[8:9], v[32:33] op_sel:[1,1,0] op_sel_hi:[0,1,1] neg_lo:[1,0,0]
    v_cvt_pk_bf16_f32 v59, v30, v32
    v_cvt_pk_bf16_f32 v75, -v31, -v33
    v_pk_mul_f32 v[28:29], v[36:37], v[16:17] op_sel:[0,0] op_sel_hi:[1,0]
    v_pk_fma_f32 v[28:29], v[36:37], v[16:17], v[28:29] op_sel:[1,1,0] op_sel_hi:[0,1,1] neg_lo:[1,0,0]
    v_cvt_pk_bf16_f32 v60, v36, v28
    v_cvt_pk_bf16_f32 v76, -v37, -v29
    v_pk_mul_f32 v[30:31], v[28:29], v[16:17] op_sel:[0,0] op_sel_hi:[1,0]
    v_pk_fma_f32 v[30:31], v[28:29], v[16:17], v[30:31] op_sel:[1,1,0] op_sel_hi:[0,1,1] neg_lo:[1,0,0]
    v_pk_mul_f32 v[34:35], v[36:37], v[12:13] op_sel:[0,0] op_sel_hi:[1,0]
    v_pk_fma_f32 v[34:35], v[36:37], v[12:13], v[34:35] op_sel:[1,1,0] op_sel_hi:[0,1,1] neg_lo:[1,0,0]
    v_pk_mul_f32 v[32:33], v[30:31], v[16:17] op_sel:[0,0] op_sel_hi:[1,0]
    v_pk_fma_f32 v[32:33], v[30:31], v[16:17], v[32:33] op_sel:[1,1,0] op_sel_hi:[0,1,1] neg_lo:[1,0,0]
    v_cvt_pk_bf16_f32 v61, v30, v32
    v_cvt_pk_bf16_f32 v77, -v31, -v33
    v_pk_mul_f32 v[28:29], v[34:35], v[18:19] op_sel:[0,0] op_sel_hi:[1,0]
    v_pk_fma_f32 v[28:29], v[34:35], v[18:19], v[28:29] op_sel:[1,1,0] op_sel_hi:[0,1,1] neg_lo:[1,0,0]
    v_pk_mul_f32 v[36:37], v[34:35], v[12:13] op_sel:[0,0] op_sel_hi:[1,0]
    v_pk_fma_f32 v[36:37], v[34:35], v[12:13], v[36:37] op_sel:[1,1,0] op_sel_hi:[0,1,1] neg_lo:[1,0,0]
    v_cvt_pk_bf16_f32 v62, v34, v28
    v_cvt_pk_bf16_f32 v78, -v35, -v29
    v_pk_mul_f32 v[28:29], v[36:37], v[18:19] op_sel:[0,0] op_sel_hi:[1,0]
    v_pk_fma_f32 v[28:29], v[36:37], v[18:19], v[28:29] op_sel:[1,1,0] op_sel_hi:[0,1,1] neg_lo:[1,0,0]
    v_cvt_pk_bf16_f32 v63, v36, v28
    v_cvt_pk_bf16_f32 v79, -v37, -v29
    v_permlane32_swap_b32 v56, v60
    v_permlane32_swap_b32 v57, v61
    v_permlane32_swap_b32 v58, v62
    v_permlane32_swap_b32 v59, v63
    v_permlane32_swap_b32 v72, v76
    v_permlane32_swap_b32 v73, v77
    v_permlane32_swap_b32 v74, v78
    v_permlane32_swap_b32 v75, v79
    v_pk_mul_f32 v[30:31], v[36:37], v[12:13] op_sel:[0,0] op_sel_hi:[1,0]
    v_pk_fma_f32 v[30:31], v[36:37], v[12:13], v[30:31] op_sel:[1,1,0] op_sel_hi:[0,1,1] neg_lo:[1,0,0]
    v_pk_mul_f32 v[32:33], v[30:31], v[12:13] op_sel:[0,0] op_sel_hi:[1,0]
    v_pk_fma_f32 v[32:33], v[30:31], v[12:13], v[32:33] op_sel:[1,1,0] op_sel_hi:[0,1,1] neg_lo:[1,0,0]
    v_cvt_pk_bf16_f32 v64, v30, v32
    v_cvt_pk_bf16_f32 v80, -v31, -v33
    v_pk_mul_f32 v[34:35], v[32:33], v[12:13] op_sel:[0,0] op_sel_hi:[1,0]
    v_pk_fma_f32 v[34:35], v[32:33], v[12:13], v[34:35] op_sel:[1,1,0] op_sel_hi:[0,1,1] neg_lo:[1,0,0]
    v_pk_mul_f32 v[28:29], v[34:35], v[12:13] op_sel:[0,0] op_sel_hi:[1,0]
    v_pk_fma_f32 v[28:29], v[34:35], v[12:13], v[28:29] op_sel:[1,1,0] op_sel_hi:[0,1,1] neg_lo:[1,0,0]
    v_cvt_pk_bf16_f32 v65, v34, v28
    v_cvt_pk_bf16_f32 v81, -v35, -v29
    v_pk_mul_f32 v[30:31], v[28:29], v[12:13] op_sel:[0,0] op_sel_hi:[1,0]
    v_pk_fma_f32 v[30:31], v[28:29], v[12:13], v[30:31] op_sel:[1,1,0] op_sel_hi:[0,1,1] neg_lo:[1,0,0]
    v_cvt_pk_bf16_f32 v66, v30, v30
    v_cvt_pk_bf16_f32 v82, -v31, -v31
    v_cvt_pk_bf16_f32 v88, v88, v89
    v_cvt_pk_bf16_f32 v89, v90, v91
    v_cvt_pk_bf16_f32 v90, v92, v93
    v_cvt_pk_bf16_f32 v91, v94, v95
    v_cvt_pk_bf16_f32 v92, v96, v97
    v_cvt_pk_bf16_f32 v93, v98, v99
    v_cvt_pk_bf16_f32 v94, v100, v101
    v_cvt_pk_bf16_f32 v95, v102, v103
    v_cvt_pk_bf16_f32 v96, v104, v105
    v_cvt_pk_bf16_f32 v97, v106, v107
    v_cvt_pk_bf16_f32 v98, v108, v109
    v_cvt_pk_bf16_f32 v99, v110, v111
    v_cvt_pk_bf16_f32 v100, v112, v113
    v_cvt_pk_bf16_f32 v101, v114, v115
    v_cvt_pk_bf16_f32 v102, v116, v117
    v_cvt_pk_bf16_f32 v103, v118, v119
    v_mfma_f32_32x32x16_bf16 v[104:119], v[56:59], v[40:43], 0
    v_cvt_pk_bf16_f32 v120, v120, v121
    v_cvt_pk_bf16_f32 v121, v122, v123
    v_cvt_pk_bf16_f32 v122, v124, v125
    v_cvt_pk_bf16_f32 v123, v126, v127
    v_cvt_pk_bf16_f32 v124, v128, v129
    v_cvt_pk_bf16_f32 v125, v130, v131
    v_cvt_pk_bf16_f32 v126, v132, v133
    v_cvt_pk_bf16_f32 v127, v134, v135
    v_mfma_f32_32x32x16_bf16 v[104:119], v[64:67], v[48:51], v[104:119]
    v_cvt_pk_bf16_f32 v128, v136, v137
    v_cvt_pk_bf16_f32 v129, v138, v139
    v_cvt_pk_bf16_f32 v130, v140, v141
    v_cvt_pk_bf16_f32 v131, v142, v143
    v_cvt_pk_bf16_f32 v132, v144, v145
    v_cvt_pk_bf16_f32 v133, v146, v147
    v_cvt_pk_bf16_f32 v134, v148, v149
    v_cvt_pk_bf16_f32 v135, v150, v151
    v_mfma_f32_32x32x16_bf16 v[136:151], v[60:63], v[40:43], 0
    s_nop 2
    v_cvt_pk_bf16_f32 v104, v104, v105
    v_cvt_pk_bf16_f32 v105, v106, v107
    v_cvt_pk_bf16_f32 v106, v108, v109
    v_cvt_pk_bf16_f32 v107, v110, v111
    v_mfma_f32_32x32x16_bf16 v[136:151], v[64:67], v[52:55], v[136:151]
    v_cvt_pk_bf16_f32 v108, v112, v113
    v_cvt_pk_bf16_f32 v109, v114, v115
    v_cvt_pk_bf16_f32 v110, v116, v117
    v_cvt_pk_bf16_f32 v111, v118, v119
    v_mfma_f32_32x32x16_bf16 v[152:167], v[104:107], v[88:91], v[152:167]
    v_and_b32 v26, 31, v0
    v_lshrrev_b32 v27, 5, v0
    v_mfma_f32_32x32x16_bf16 v[152:167], v[108:111], v[92:95], v[152:167]
    v_lshlrev_b32 v28, 5, v26
    v_lshl_add_u32 v28, v27, 4, v28
    v_mfma_f32_32x32x16_bf16 v[104:119], v[72:75], v[40:43], 0
    v_add_u32 v28, s29, v28
    v_lshlrev_b32 v29, 4, v26
    v_mfma_f32_32x32x16_bf16 v[104:119], v[80:83], v[48:51], v[104:119]
    v_add_u32 v29, 1024, v29
    v_add_u32 v30, 8, v29
    s_mov_b32 exec_lo, 0
    v_lshlrev_b32 v29, 3, v26
    v_add_u32 v29, 1536, v29
    v_add_u32 v30, 256, v29
    s_mov_b32 exec_lo, -1
    v_cvt_pk_bf16_f32 v136, v136, v137
    v_cvt_pk_bf16_f32 v137, v138, v139
    v_cvt_pk_bf16_f32 v138, v140, v141
    v_cvt_pk_bf16_f32 v139, v142, v143
    v_cvt_pk_bf16_f32 v140, v144, v145
    v_cvt_pk_bf16_f32 v141, v146, v147
    v_cvt_pk_bf16_f32 v142, v148, v149
    v_cvt_pk_bf16_f32 v143, v150, v151
    v_mfma_f32_32x32x16_bf16 v[152:167], v[136:139], v[96:99], v[152:167]
    v_add_u32 v29, s29, v29
    v_add_u32 v30, s29, v30
    v_lshlrev_b32 v31, 2, v26
    v_mfma_f32_32x32x16_bf16 v[152:167], v[140:143], v[100:103], v[152:167]
    v_lshl_add_u32 v31, v27, 9, v31
    v_add_u32 v31, s29, v31
    v_mov_b32 v32, 160032
    v_mfma_f32_32x32x16_bf16 v[136:151], v[76:79], v[40:43], 0
    s_and_b32 s20, s3, 1
    s_lshl_b32 s20, s20, 2
    v_add_u32 v32, s20, v32
    v_mfma_f32_32x32x16_bf16 v[136:151], v[80:83], v[52:55], v[136:151]
    v_mov_b32 v33, 1
    v_cvt_pk_bf16_f32 v104, v104, v105
    v_cvt_pk_bf16_f32 v105, v106, v107
    v_cvt_pk_bf16_f32 v106, v108, v109
    v_cvt_pk_bf16_f32 v107, v110, v111
    v_cvt_pk_bf16_f32 v108, v112, v113
    v_cvt_pk_bf16_f32 v109, v114, v115
    v_cvt_pk_bf16_f32 v110, v116, v117
    v_cvt_pk_bf16_f32 v111, v118, v119
    v_mfma_f32_32x32x16_bf16 v[152:167], v[104:107], v[120:123], v[152:167]
    s_nop 0
    v_mfma_f32_32x32x16_bf16 v[152:167], v[108:111], v[124:127], v[152:167]
    v_cvt_pk_bf16_f32 v136, v136, v137
    v_cvt_pk_bf16_f32 v137, v138, v139
    v_cvt_pk_bf16_f32 v138, v140, v141
    v_cvt_pk_bf16_f32 v139, v142, v143
    v_cvt_pk_bf16_f32 v140, v144, v145
    v_cvt_pk_bf16_f32 v141, v146, v147
    v_cvt_pk_bf16_f32 v142, v148, v149
    v_cvt_pk_bf16_f32 v143, v150, v151
    v_mfma_f32_32x32x16_bf16 v[152:167], v[136:139], v[128:131], v[152:167]
    s_nop 0
    v_mfma_f32_32x32x16_bf16 v[152:167], v[140:143], v[132:135], v[152:167]
    s_nop 11
    ds_write_b128 v28, v[152:155]
    ds_write_b64 v29, v[156:157]
    ds_write_b64 v30, v[158:159]
    ds_write_b32 v31, v160 offset:2048
    ds_write_b32 v31, v161 offset:2176
    ds_write_b32 v31, v162 offset:2304
    ds_write_b32 v31, v163 offset:2432
    s_mov_b64 exec, 1
    ds_add_u32 v32, v33 offset:0
    s_mov_b64 exec, -1
    s_and_b32 s20, s3, 1
    s_lshl_b32 s20, s20, 12
    s_add_u32 s31, s20, 143616
    s_mul_i32 s30, s22, 4224
    s_add_u32 s30, s30, 8388608
    v_lshlrev_b32 v34, 4, v0
    v_sub_u32 v34, 4080, v34
    v_lshlrev_b32 v35, 2, v0
    v_add_u32 v35, s31, v35
    v_and_b32 v36, 1, v0
    v_cmp_eq_u32 s[66:67], 1, v36
k1_kernel_poll_48:
    ds_read_b32 v26, v32 offset:0
    s_waitcnt lgkmcnt(0)
    v_readfirstlane_b32 s20, v26
    s_cmp_lt_u32 s20, 2
    s_cbranch_scc1 k1_kernel_poll_48
    s_cmp_eq_u32 s23, 1
    s_cbranch_scc1 k1_exp1
    v_lshlrev_b32 v38, 5, v0
    s_mov_b32 exec_lo, 0
    v_lshlrev_b32 v38, 4, v0
    v_add_u32 v38, 512, v38
    s_mov_b32 exec_lo, -1
    v_add_u32 v38, s31, v38
    ds_read_b128 v[48:51], v38
    ds_read_b128 v[52:55], v38 offset:16
    ds_read_b128 v[56:59], v38 offset:8192
    ds_read_b128 v[60:63], v38 offset:8208
    v_add_u32 v37, 2048, v35
    ds_read2_b32 v[64:65], v37 offset0:0 offset1:1
    v_add_u32 v37, 8192, v37
    ds_read2_b32 v[66:67], v37 offset0:0 offset1:1
    s_waitcnt lgkmcnt(0)
    v_add_f32 v48, v48, v56
    v_add_f32 v49, v49, v57
    v_add_f32 v50, v50, v58
    v_add_f32 v51, v51, v59
    v_add_f32 v52, v52, v60
    v_add_f32 v53, v53, v61
    v_add_f32 v54, v54, v62
    v_add_f32 v55, v55, v63
    s_mov_b32 exec_lo, 0
    v_mov_b32 v55, v52
    v_mov_b32 v54, v51
    v_mov_b32 v53, v50
    v_mov_b32 v52, v50
    v_mov_b32 v51, v50
    v_mov_b32 v50, v49
    v_mov_b32 v49, v48
    s_mov_b64 exec, 1
    v_add_f32 v48, s63, v48
    s_mov_b64 exec, -1
    v_cvt_pk_bf16_f32 v56, v55, v54
    v_cvt_pk_bf16_f32 v57, v53, v52
    v_cvt_pk_bf16_f32 v58, v51, v50
    v_cvt_pk_bf16_f32 v59, v49, v48
    buffer_store_dwordx4 v[56:59], v34, s[16:19], s30 offen sc0 sc1
    v_add_f32 v64, v64, v66
    v_add_f32 v65, v65, v67
    v_cndmask_b32 v66, v64, v65, s[66:67]
    v_cvt_pk_bf16_f32 v68, v65, v65
    v_cvt_pk_bf16_f32 v69, v65, v66
    v_cvt_pk_bf16_f32 v70, v64, v64
    v_cvt_pk_bf16_f32 v71, v64, v64
    s_sub_u32 s20, s30, 2048
    buffer_store_dwordx4 v[68:71], v34, s[16:19], s20 offen sc0 sc1
    s_add_u32 s3, s3, 4
    s_waitcnt vmcnt(0) lgkmcnt(0)
    s_branch k2_entry
k1_exp1:
    v_lshlrev_b32 v38, 3, v0
    v_add_u32 v38, s31, v38
    ds_read_b64 v[48:49], v38 offset:1536
    ds_read_b32 v50, v38 offset:1544
    ds_read_b64 v[52:53], v38 offset:9728
    ds_read_b32 v54, v38 offset:9736
    v_add_u32 v37, 2304, v35
    ds_read2_b32 v[64:65], v37 offset0:0 offset1:1
    v_add_u32 v37, 8192, v37
    ds_read2_b32 v[66:67], v37 offset0:0 offset1:1
    v_mov_b32 v72, 0
    v_mov_b32 v73, 0
    v_mov_b32 v74, 0
    v_mov_b32 v75, 0
    v_lshlrev_b32 v39, 4, v0
    s_add_u32 s21, s30, 4096
    s_mov_b64 exec, 0xff
    buffer_store_dwordx4 v[72:75], v39, s[16:19], s21 offen sc0 sc1
    s_mov_b64 exec, -1
    s_waitcnt lgkmcnt(0)
    v_add_f32 v48, v48, v52
    v_add_f32 v49, v49, v53
    v_add_f32 v50, v50, v54
    v_cvt_pk_bf16_f32 v56, v50, v50
    v_cvt_pk_bf16_f32 v57, v49, v49
    v_cvt_pk_bf16_f32 v58, v49, v48
    v_cvt_pk_bf16_f32 v59, v48, v48
    s_sub_u32 s20, s30, 1024
    buffer_store_dwordx4 v[56:59], v34, s[16:19], s20 offen sc0 sc1
    v_add_f32 v64, v64, v66
    v_add_f32 v65, v65, v67
    v_cndmask_b32 v66, v64, v65, s[66:67]
    v_cvt_pk_bf16_f32 v68, v65, v65
    v_cvt_pk_bf16_f32 v69, v65, v66
    v_cvt_pk_bf16_f32 v70, v64, v64
    v_cvt_pk_bf16_f32 v71, v64, v64
    s_sub_u32 s20, s30, 3072
    buffer_store_dwordx4 v[68:71], v34, s[16:19], s20 offen sc0 sc1
    s_add_u32 s3, s3, 4
    s_waitcnt vmcnt(0) lgkmcnt(0)
    s_branch k2_entry
k1_loader:
    s_load_dwordx2 s[62:63], s[0:1], 104
    s_setprio 3
    v_add_u32 v4, 0, v0
    v_mul_u32_u24 v5, 171, v4
    v_lshrrev_b32 v5, 11, v5
    v_mul_u32_u24 v6, 12, v5
    v_sub_u32 v4, v4, v6
    v_mul_u32_u24 v5, 2688, v5
    v_lshl_add_u32 v8, v4, 4, v5
    v_add_u32 v4, 64, v0
    v_mul_u32_u24 v5, 171, v4
    v_lshrrev_b32 v5, 11, v5
    v_mul_u32_u24 v6, 12, v5
    v_sub_u32 v4, v4, v6
    v_mul_u32_u24 v5, 2688, v5
    v_lshl_add_u32 v9, v4, 4, v5
    v_subrev_u32 v9, 1024, v9
    v_add_u32 v4, 128, v0
    v_mul_u32_u24 v5, 171, v4
    v_lshrrev_b32 v5, 11, v5
    v_mul_u32_u24 v6, 12, v5
    v_sub_u32 v4, v4, v6
    v_mul_u32_u24 v5, 2688, v5
    v_lshl_add_u32 v10, v4, 4, v5
    v_subrev_u32 v10, 2048, v10
    v_lshrrev_b32 v5, 3, v0
    v_mul_u32_u24 v5, 896, v5
    v_lshrrev_b32 v6, 4, v0
    v_and_b32 v7, 7, v0
    v_xor_b32 v6, v6, v7
    v_lshl_add_u32 v26, v6, 4, v5
    v_xor_b32 v6, 4, v6
    v_lshl_add_u32 v27, v6, 4, v5
    v_add_u32 v28, 12288, v26
    v_add_u32 v29, 18432, v27
    v_add_u32 v27, 6144, v27
    s_mul_i32 s24, s5, 114688
    s_mul_i32 s33, s4, 192
    v_mov_b32 v11, 160000
    v_mov_b32 v12, 1
    s_waitcnt lgkmcnt(0)
    s_mov_b32 s12, s38
    s_mov_b32 s13, s39
    s_mov_b32 s14, 1204224
    s_mov_b32 s15, 0x00020000
    v_mov_b32 v31, 0
    s_mov_b32 s8, s36
    s_mov_b32 s9, s37
    s_mov_b32 s10, 1835008
    s_mov_b32 s11, 0x00020000
    s_mov_b32 s59, s33
    s_add_u32 s58, s33, 1204224
    s_mul_i32 s20, s35, 172032
    s_add_u32 s33, s33, s20
    s_mov_b32 s57, s24
    s_lshl_b32 s20, s35, 7
    s_add_u32 s24, s24, s20
    s_barrier
    s_mov_b32 m0, 256
    s_add_u32 s20, s33, 0
    buffer_load_dwordx4 v8, s[12:15], s20 offen lds
    buffer_load_dwordx4 v9, s[12:15], s20 offen offset:1024 lds
    buffer_load_dwordx4 v10, s[12:15], s20 offen offset:2048 lds
    s_mov_b32 m0, 3328
    s_add_u32 s20, s33, 43008
    buffer_load_dwordx4 v8, s[12:15], s20 offen lds
    buffer_load_dwordx4 v9, s[12:15], s20 offen offset:1024 lds
    buffer_load_dwordx4 v10, s[12:15], s20 offen offset:2048 lds
    s_mov_b32 m0, 6400
    s_add_u32 s20, s33, 86016
    buffer_load_dwordx4 v8, s[12:15], s20 offen lds
    buffer_load_dwordx4 v9, s[12:15], s20 offen offset:1024 lds
    buffer_load_dwordx4 v10, s[12:15], s20 offen offset:2048 lds
    s_mov_b32 m0, 9472
    s_add_u32 s20, s33, 129024
    buffer_load_dwordx4 v8, s[12:15], s20 offen lds
    buffer_load_dwordx4 v9, s[12:15], s20 offen offset:1024 lds
    buffer_load_dwordx4 v10, s[12:15], s20 offen offset:2048 lds
    s_mov_b32 m0, 12544
    s_add_u32 s20, s24, 0
    buffer_load_dwordx4 v26, s[8:11], s20 offen lds
    buffer_load_dwordx4 v27, s[8:11], s20 offen offset:1024 lds
    buffer_load_dwordx4 v28, s[8:11], s20 offen offset:2048 lds
    buffer_load_dwordx4 v29, s[8:11], s20 offen offset:3072 lds
    s_mov_b32 m0, 16640
    s_add_u32 s20, s24, 28672
    buffer_load_dwordx4 v26, s[8:11], s20 offen lds
    buffer_load_dwordx4 v27, s[8:11], s20 offen offset:1024 lds
    buffer_load_dwordx4 v28, s[8:11], s20 offen offset:2048 lds
    buffer_load_dwordx4 v29, s[8:11], s20 offen offset:3072 lds
    s_mov_b32 m0, 20736
    s_add_u32 s20, s24, 57344
    buffer_load_dwordx4 v26, s[8:11], s20 offen lds
    buffer_load_dwordx4 v27, s[8:11], s20 offen offset:1024 lds
    buffer_load_dwordx4 v28, s[8:11], s20 offen offset:2048 lds
    buffer_load_dwordx4 v29, s[8:11], s20 offen offset:3072 lds
    s_mov_b32 m0, 24832
    s_add_u32 s20, s24, 86016
    buffer_load_dwordx4 v26, s[8:11], s20 offen lds
    buffer_load_dwordx4 v27, s[8:11], s20 offen offset:1024 lds
    buffer_load_dwordx4 v28, s[8:11], s20 offen offset:2048 lds
    buffer_load_dwordx4 v29, s[8:11], s20 offen offset:3072 lds
    s_add_u32 s33, s33, 172032
    s_add_u32 s24, s24, 128
    s_cmp_eq_u32 s33, s58
    s_cselect_b32 s33, s59, s33
    s_cselect_b32 s24, s57, s24
    s_mov_b32 m0, 28928
    s_add_u32 s20, s33, 0
    buffer_load_dwordx4 v8, s[12:15], s20 offen lds
    buffer_load_dwordx4 v9, s[12:15], s20 offen offset:1024 lds
    buffer_load_dwordx4 v10, s[12:15], s20 offen offset:2048 lds
    s_mov_b32 m0, 32000
    s_add_u32 s20, s33, 43008
    buffer_load_dwordx4 v8, s[12:15], s20 offen lds
    buffer_load_dwordx4 v9, s[12:15], s20 offen offset:1024 lds
    buffer_load_dwordx4 v10, s[12:15], s20 offen offset:2048 lds
    s_mov_b32 m0, 35072
    s_add_u32 s20, s33, 86016
    buffer_load_dwordx4 v8, s[12:15], s20 offen lds
    buffer_load_dwordx4 v9, s[12:15], s20 offen offset:1024 lds
    buffer_load_dwordx4 v10, s[12:15], s20 offen offset:2048 lds
    s_mov_b32 m0, 38144
    s_add_u32 s20, s33, 129024
    buffer_load_dwordx4 v8, s[12:15], s20 offen lds
    buffer_load_dwordx4 v9, s[12:15], s20 offen offset:1024 lds
    buffer_load_dwordx4 v10, s[12:15], s20 offen offset:2048 lds
    s_mov_b32 m0, 41216
    s_add_u32 s20, s24, 0
    buffer_load_dwordx4 v26, s[8:11], s20 offen lds
    buffer_load_dwordx4 v27, s[8:11], s20 offen offset:1024 lds
    buffer_load_dwordx4 v28, s[8:11], s20 offen offset:2048 lds
    buffer_load_dwordx4 v29, s[8:11], s20 offen offset:3072 lds
    s_mov_b32 m0, 45312
    s_add_u32 s20, s24, 28672
    buffer_load_dwordx4 v26, s[8:11], s20 offen lds
    buffer_load_dwordx4 v27, s[8:11], s20 offen offset:1024 lds
    buffer_load_dwordx4 v28, s[8:11], s20 offen offset:2048 lds
    buffer_load_dwordx4 v29, s[8:11], s20 offen offset:3072 lds
    s_mov_b32 m0, 49408
    s_add_u32 s20, s24, 57344
    buffer_load_dwordx4 v26, s[8:11], s20 offen lds
    buffer_load_dwordx4 v27, s[8:11], s20 offen offset:1024 lds
    buffer_load_dwordx4 v28, s[8:11], s20 offen offset:2048 lds
    buffer_load_dwordx4 v29, s[8:11], s20 offen offset:3072 lds
    s_mov_b32 m0, 53504
    s_add_u32 s20, s24, 86016
    buffer_load_dwordx4 v26, s[8:11], s20 offen lds
    buffer_load_dwordx4 v27, s[8:11], s20 offen offset:1024 lds
    buffer_load_dwordx4 v28, s[8:11], s20 offen offset:2048 lds
    buffer_load_dwordx4 v29, s[8:11], s20 offen offset:3072 lds
    s_add_u32 s33, s33, 172032
    s_add_u32 s24, s24, 128
    s_cmp_eq_u32 s33, s58
    s_cselect_b32 s33, s59, s33
    s_cselect_b32 s24, s57, s24
    s_mov_b32 s28, s42
    s_mov_b32 s29, s43
    s_mov_b32 s30, 1835008
    s_mov_b32 s31, 0x00020000
    s_mov_b32 s16, s60
    s_mov_b32 s17, s61
    s_mov_b32 s18, 14680064
    s_mov_b32 s19, 0x00020000
    v_lshrrev_b32 v13, 2, v0
    v_mul_u32_u24 v13, 896, v13
    v_and_b32 v14, 3, v0
    v_lshl_add_u32 v13, v14, 4, v13
    s_mul_i32 s20, s4, 224736
    s_lshr_b32 s20, s20, 16
    v_add_u32 v14, s20, v0
    v_mul_u32_u24 v15, 28, v14
    s_mul_i32 s20, s4, 96
    s_add_u32 s20, s20, 96
    v_cmp_gt_u32 vcc, s20, v15
    v_and_b32 v16, 15, v14
    s_lshr_b32 s20, s5, 2
    s_lshl_b32 s20, s20, 7
    s_add_u32 s20, s20, 10371072
    v_lshl_add_u32 v15, v16, 9, s20
    v_bfrev_b32 v14, 1
    v_cndmask_b32 v130, v14, v15, vcc
    s_lshl_b32 s26, s2, 2
    s_add_u32 s26, s26, 0
    s_mul_i32 s27, s26, 4682
    s_lshr_b32 s27, s27, 16
    s_mul_i32 s20, s27, 14
    s_sub_u32 s26, s26, s20
    s_lshl_b32 s20, s26, 7
    s_add_u32 s20, s20, 10379264
    v_writelane_b32 v130, s20, 8
    s_mul_i32 s40, s27, 28672
    s_lshl_b32 s20, s26, 6
    s_add_u32 s40, s40, s20
    s_lshl_b32 s44, s26, 17
    s_lshl_b32 s20, s27, 6
    s_add_u32 s44, s44, s20
    s_add_u32 s44, s44, 10485760
    s_lshl_b32 s26, s2, 2
    s_add_u32 s26, s26, 1
    s_mul_i32 s27, s26, 4682
    s_lshr_b32 s27, s27, 16
    s_mul_i32 s20, s27, 14
    s_sub_u32 s26, s26, s20
    s_lshl_b32 s20, s26, 7
    s_add_u32 s20, s20, 10379264
    v_writelane_b32 v130, s20, 9
    s_mul_i32 s41, s27, 28672
    s_lshl_b32 s20, s26, 6
    s_add_u32 s41, s41, s20
    s_lshl_b32 s45, s26, 17
    s_lshl_b32 s20, s27, 6
    s_add_u32 s45, s45, s20
    s_add_u32 s45, s45, 10485760
    s_lshl_b32 s26, s2, 2
    s_add_u32 s26, s26, 2
    s_mul_i32 s27, s26, 4682
    s_lshr_b32 s27, s27, 16
    s_mul_i32 s20, s27, 14
    s_sub_u32 s26, s26, s20
    s_lshl_b32 s20, s26, 7
    s_add_u32 s20, s20, 10379264
    v_writelane_b32 v130, s20, 10
    s_mul_i32 s42, s27, 28672
    s_lshl_b32 s20, s26, 6
    s_add_u32 s42, s42, s20
    s_lshl_b32 s46, s26, 17
    s_lshl_b32 s20, s27, 6
    s_add_u32 s46, s46, s20
    s_add_u32 s46, s46, 10485760
    s_lshl_b32 s26, s2, 2
    s_add_u32 s26, s26, 3
    s_mul_i32 s27, s26, 4682
    s_lshr_b32 s27, s27, 16
    s_mul_i32 s20, s27, 14
    s_sub_u32 s26, s26, s20
    s_lshl_b32 s20, s26, 7
    s_add_u32 s20, s20, 10379264
    v_writelane_b32 v130, s20, 11
    s_mul_i32 s43, s27, 28672
    s_lshl_b32 s20, s26, 6
    s_add_u32 s43, s43, s20
    s_lshl_b32 s47, s26, 17
    s_lshl_b32 s20, s27, 6
    s_add_u32 s47, s47, s20
    s_add_u32 s47, s47, 10485760
    s_mov_b32 m0, 57600
    s_add_u32 s20, s33, 0
    buffer_load_dwordx4 v8, s[12:15], s20 offen lds
    buffer_load_dwordx4 v9, s[12:15], s20 offen offset:1024 lds
    buffer_load_dwordx4 v10, s[12:15], s20 offen offset:2048 lds
    s_mov_b32 m0, 60672
    s_add_u32 s20, s33, 43008
    buffer_load_dwordx4 v8, s[12:15], s20 offen lds
    buffer_load_dwordx4 v9, s[12:15], s20 offen offset:1024 lds
    buffer_load_dwordx4 v10, s[12:15], s20 offen offset:2048 lds
    s_mov_b32 m0, 63744
    s_add_u32 s20, s33, 86016
    buffer_load_dwordx4 v8, s[12:15], s20 offen lds
    buffer_load_dwordx4 v9, s[12:15], s20 offen offset:1024 lds
    buffer_load_dwordx4 v10, s[12:15], s20 offen offset:2048 lds
    s_mov_b32 m0, 66816
    s_add_u32 s20, s33, 129024
    buffer_load_dwordx4 v8, s[12:15], s20 offen lds
    buffer_load_dwordx4 v9, s[12:15], s20 offen offset:1024 lds
    buffer_load_dwordx4 v10, s[12:15], s20 offen offset:2048 lds
    s_mov_b32 m0, 69888
    s_add_u32 s20, s24, 0
    buffer_load_dwordx4 v26, s[8:11], s20 offen lds
    buffer_load_dwordx4 v27, s[8:11], s20 offen offset:1024 lds
    buffer_load_dwordx4 v28, s[8:11], s20 offen offset:2048 lds
    buffer_load_dwordx4 v29, s[8:11], s20 offen offset:3072 lds
    s_waitcnt vmcnt(44)
    s_mov_b64 exec, 1
    ds_add_u32 v11, v12 offset:0
    s_mov_b64 exec, -1
    s_mov_b32 m0, 73984
    s_add_u32 s20, s24, 28672
    buffer_load_dwordx4 v26, s[8:11], s20 offen lds
    buffer_load_dwordx4 v27, s[8:11], s20 offen offset:1024 lds
    buffer_load_dwordx4 v28, s[8:11], s20 offen offset:2048 lds
    buffer_load_dwordx4 v29, s[8:11], s20 offen offset:3072 lds
    s_mov_b32 m0, 78080
    s_add_u32 s20, s24, 57344
    buffer_load_dwordx4 v26, s[8:11], s20 offen lds
    buffer_load_dwordx4 v27, s[8:11], s20 offen offset:1024 lds
    buffer_load_dwordx4 v28, s[8:11], s20 offen offset:2048 lds
    buffer_load_dwordx4 v29, s[8:11], s20 offen offset:3072 lds
    s_mov_b32 m0, 82176
    s_add_u32 s20, s24, 86016
    buffer_load_dwordx4 v26, s[8:11], s20 offen lds
    buffer_load_dwordx4 v27, s[8:11], s20 offen offset:1024 lds
    buffer_load_dwordx4 v28, s[8:11], s20 offen offset:2048 lds
    buffer_load_dwordx4 v29, s[8:11], s20 offen offset:3072 lds
    s_add_u32 s33, s33, 172032
    s_add_u32 s24, s24, 128
    s_cmp_eq_u32 s33, s58
    s_cselect_b32 s33, s59, s33
    s_cselect_b32 s24, s57, s24
    s_mov_b32 m0, 86272
    s_add_u32 s20, s33, 0
    buffer_load_dwordx4 v8, s[12:15], s20 offen lds
    buffer_load_dwordx4 v9, s[12:15], s20 offen offset:1024 lds
    buffer_load_dwordx4 v10, s[12:15], s20 offen offset:2048 lds
    s_mov_b32 m0, 89344
    s_add_u32 s20, s33, 43008
    buffer_load_dwordx4 v8, s[12:15], s20 offen lds
    buffer_load_dwordx4 v9, s[12:15], s20 offen offset:1024 lds
    buffer_load_dwordx4 v10, s[12:15], s20 offen offset:2048 lds
    s_mov_b32 m0, 92416
    s_add_u32 s20, s33, 86016
    buffer_load_dwordx4 v8, s[12:15], s20 offen lds
    buffer_load_dwordx4 v9, s[12:15], s20 offen offset:1024 lds
    buffer_load_dwordx4 v10, s[12:15], s20 offen offset:2048 lds
    s_mov_b32 m0, 95488
    s_add_u32 s20, s33, 129024
    buffer_load_dwordx4 v8, s[12:15], s20 offen lds
    buffer_load_dwordx4 v9, s[12:15], s20 offen offset:1024 lds
    buffer_load_dwordx4 v10, s[12:15], s20 offen offset:2048 lds
    s_mov_b32 m0, 98560
    s_add_u32 s20, s24, 0
    buffer_load_dwordx4 v26, s[8:11], s20 offen lds
    buffer_load_dwordx4 v27, s[8:11], s20 offen offset:1024 lds
    buffer_load_dwordx4 v28, s[8:11], s20 offen offset:2048 lds
    buffer_load_dwordx4 v29, s[8:11], s20 offen offset:3072 lds
    s_waitcnt vmcnt(44)
    s_mov_b64 exec, 1
    ds_add_u32 v11, v12 offset:4
    s_mov_b64 exec, -1
    s_mov_b32 m0, 102656
    s_add_u32 s20, s24, 28672
    buffer_load_dwordx4 v26, s[8:11], s20 offen lds
    buffer_load_dwordx4 v27, s[8:11], s20 offen offset:1024 lds
    buffer_load_dwordx4 v28, s[8:11], s20 offen offset:2048 lds
    buffer_load_dwordx4 v29, s[8:11], s20 offen offset:3072 lds
    s_mov_b32 m0, 106752
    s_add_u32 s20, s24, 57344
    buffer_load_dwordx4 v26, s[8:11], s20 offen lds
    buffer_load_dwordx4 v27, s[8:11], s20 offen offset:1024 lds
    buffer_load_dwordx4 v28, s[8:11], s20 offen offset:2048 lds
    buffer_load_dwordx4 v29, s[8:11], s20 offen offset:3072 lds
    s_mov_b32 m0, 110848
    s_add_u32 s20, s24, 86016
    buffer_load_dwordx4 v26, s[8:11], s20 offen lds
    buffer_load_dwordx4 v27, s[8:11], s20 offen offset:1024 lds
    buffer_load_dwordx4 v28, s[8:11], s20 offen offset:2048 lds
    buffer_load_dwordx4 v29, s[8:11], s20 offen offset:3072 lds
    s_add_u32 s33, s33, 172032
    s_add_u32 s24, s24, 128
    s_cmp_eq_u32 s33, s58
    s_cselect_b32 s33, s59, s33
    s_cselect_b32 s24, s57, s24
    s_mov_b32 m0, 114944
    s_add_u32 s20, s33, 0
    buffer_load_dwordx4 v8, s[12:15], s20 offen lds
    buffer_load_dwordx4 v9, s[12:15], s20 offen offset:1024 lds
    buffer_load_dwordx4 v10, s[12:15], s20 offen offset:2048 lds
    s_mov_b32 m0, 118016
    s_add_u32 s20, s33, 43008
    buffer_load_dwordx4 v8, s[12:15], s20 offen lds
    buffer_load_dwordx4 v9, s[12:15], s20 offen offset:1024 lds
    buffer_load_dwordx4 v10, s[12:15], s20 offen offset:2048 lds
    s_mov_b32 m0, 121088
    s_add_u32 s20, s33, 86016
    buffer_load_dwordx4 v8, s[12:15], s20 offen lds
    buffer_load_dwordx4 v9, s[12:15], s20 offen offset:1024 lds
    buffer_load_dwordx4 v10, s[12:15], s20 offen offset:2048 lds
    s_mov_b32 m0, 124160
    s_add_u32 s20, s33, 129024
    buffer_load_dwordx4 v8, s[12:15], s20 offen lds
    buffer_load_dwordx4 v9, s[12:15], s20 offen offset:1024 lds
    buffer_load_dwordx4 v10, s[12:15], s20 offen offset:2048 lds
    s_mov_b32 m0, 127232
    s_add_u32 s20, s24, 0
    buffer_load_dwordx4 v26, s[8:11], s20 offen lds
    buffer_load_dwordx4 v27, s[8:11], s20 offen offset:1024 lds
    buffer_load_dwordx4 v28, s[8:11], s20 offen offset:2048 lds
    buffer_load_dwordx4 v29, s[8:11], s20 offen offset:3072 lds
    s_waitcnt vmcnt(44)
    s_mov_b64 exec, 1
    ds_add_u32 v11, v12 offset:8
    s_mov_b64 exec, -1
    s_mov_b32 m0, 131328
    s_add_u32 s20, s24, 28672
    buffer_load_dwordx4 v26, s[8:11], s20 offen lds
    buffer_load_dwordx4 v27, s[8:11], s20 offen offset:1024 lds
    buffer_load_dwordx4 v28, s[8:11], s20 offen offset:2048 lds
    buffer_load_dwordx4 v29, s[8:11], s20 offen offset:3072 lds
    s_mov_b32 m0, 135424
    s_add_u32 s20, s24, 57344
    buffer_load_dwordx4 v26, s[8:11], s20 offen lds
    buffer_load_dwordx4 v27, s[8:11], s20 offen offset:1024 lds
    buffer_load_dwordx4 v28, s[8:11], s20 offen offset:2048 lds
    buffer_load_dwordx4 v29, s[8:11], s20 offen offset:3072 lds
    s_mov_b32 m0, 139520
    s_add_u32 s20, s24, 86016
    buffer_load_dwordx4 v26, s[8:11], s20 offen lds
    buffer_load_dwordx4 v27, s[8:11], s20 offen offset:1024 lds
    buffer_load_dwordx4 v28, s[8:11], s20 offen offset:2048 lds
    buffer_load_dwordx4 v29, s[8:11], s20 offen offset:3072 lds
    s_add_u32 s33, s33, 172032
    s_add_u32 s24, s24, 128
    s_cmp_eq_u32 s33, s58
    s_cselect_b32 s33, s59, s33
    s_cselect_b32 s24, s57, s24
    s_add_u32 s20, s40, 0
    buffer_load_dwordx4 v[96:99], v13, s[28:31], s20 offen
    s_add_u32 s20, s41, 0
    buffer_load_dwordx4 v[104:107], v13, s[28:31], s20 offen
    s_add_u32 s20, s42, 0
    buffer_load_dwordx4 v[112:115], v13, s[28:31], s20 offen
    s_add_u32 s20, s43, 0
    buffer_load_dwordx4 v[120:123], v13, s[28:31], s20 offen
    s_add_u32 s20, s40, 14336
    buffer_load_dwordx4 v[100:103], v13, s[28:31], s20 offen
    s_add_u32 s20, s41, 14336
    buffer_load_dwordx4 v[108:111], v13, s[28:31], s20 offen
    s_add_u32 s20, s42, 14336
    buffer_load_dwordx4 v[116:119], v13, s[28:31], s20 offen
    s_add_u32 s20, s43, 14336
    buffer_load_dwordx4 v[124:127], v13, s[28:31], s20 offen
    global_load_dword v131, v31, s[62:63] offset:128 sc1
k1_kernel_poll_49:
    ds_read_b32 v4, v11 offset:40
    s_waitcnt lgkmcnt(0)
    v_readfirstlane_b32 s20, v4
    s_cmp_lt_u32 s20, 4
    s_cbranch_scc1 k1_kernel_poll_49
    s_mov_b32 m0, 256
    s_add_u32 s20, s33, 0
    s_nop 0
    buffer_load_dwordx4 v8, s[12:15], s20 offen lds
    buffer_load_dwordx4 v9, s[12:15], s20 offen offset:1024 lds
    buffer_load_dwordx4 v10, s[12:15], s20 offen offset:2048 lds
    s_mov_b32 m0, 3328
    s_add_u32 s20, s33, 43008
    buffer_load_dwordx4 v8, s[12:15], s20 offen lds
    buffer_load_dwordx4 v9, s[12:15], s20 offen offset:1024 lds
    buffer_load_dwordx4 v10, s[12:15], s20 offen offset:2048 lds
    s_waitcnt vmcnt(43)
    s_mov_b64 exec, 1
    ds_add_u32 v11, v12 offset:12
    s_mov_b64 exec, -1
    s_mov_b32 m0, 6400
    s_add_u32 s20, s33, 86016
    buffer_load_dwordx4 v8, s[12:15], s20 offen lds
    buffer_load_dwordx4 v9, s[12:15], s20 offen offset:1024 lds
    buffer_load_dwordx4 v10, s[12:15], s20 offen offset:2048 lds
    s_mov_b32 m0, 9472
    s_add_u32 s20, s33, 129024
    buffer_load_dwordx4 v8, s[12:15], s20 offen lds
    buffer_load_dwordx4 v9, s[12:15], s20 offen offset:1024 lds
    buffer_load_dwordx4 v10, s[12:15], s20 offen offset:2048 lds
    s_mov_b32 m0, 12544
    s_add_u32 s20, s24, 0
    buffer_load_dwordx4 v26, s[8:11], s20 offen lds
    buffer_load_dwordx4 v27, s[8:11], s20 offen offset:1024 lds
    buffer_load_dwordx4 v28, s[8:11], s20 offen offset:2048 lds
    buffer_load_dwordx4 v29, s[8:11], s20 offen offset:3072 lds
    s_mov_b32 m0, 16640
    s_add_u32 s20, s24, 28672
    buffer_load_dwordx4 v26, s[8:11], s20 offen lds
    buffer_load_dwordx4 v27, s[8:11], s20 offen offset:1024 lds
    buffer_load_dwordx4 v28, s[8:11], s20 offen offset:2048 lds
    buffer_load_dwordx4 v29, s[8:11], s20 offen offset:3072 lds
    s_mov_b32 m0, 20736
    s_add_u32 s20, s24, 57344
    buffer_load_dwordx4 v26, s[8:11], s20 offen lds
    buffer_load_dwordx4 v27, s[8:11], s20 offen offset:1024 lds
    buffer_load_dwordx4 v28, s[8:11], s20 offen offset:2048 lds
    buffer_load_dwordx4 v29, s[8:11], s20 offen offset:3072 lds
    s_mov_b32 m0, 24832
    s_add_u32 s20, s24, 86016
    buffer_load_dwordx4 v26, s[8:11], s20 offen lds
    buffer_load_dwordx4 v27, s[8:11], s20 offen offset:1024 lds
    buffer_load_dwordx4 v28, s[8:11], s20 offen offset:2048 lds
    buffer_load_dwordx4 v29, s[8:11], s20 offen offset:3072 lds
    s_add_u32 s33, s33, 172032
    s_add_u32 s24, s24, 128
    s_cmp_eq_u32 s33, s58
    s_cselect_b32 s33, s59, s33
    s_cselect_b32 s24, s57, s24
k1_kernel_poll_50:
    ds_read_b32 v4, v11 offset:44
    s_waitcnt lgkmcnt(0)
    v_readfirstlane_b32 s20, v4
    s_cmp_lt_u32 s20, 4
    s_cbranch_scc1 k1_kernel_poll_50
    s_mov_b32 m0, 28928
    s_add_u32 s20, s33, 0
    s_nop 0
    buffer_load_dwordx4 v8, s[12:15], s20 offen lds
    buffer_load_dwordx4 v9, s[12:15], s20 offen offset:1024 lds
    buffer_load_dwordx4 v10, s[12:15], s20 offen offset:2048 lds
    s_mov_b32 m0, 32000
    s_add_u32 s20, s33, 43008
    buffer_load_dwordx4 v8, s[12:15], s20 offen lds
    buffer_load_dwordx4 v9, s[12:15], s20 offen offset:1024 lds
    buffer_load_dwordx4 v10, s[12:15], s20 offen offset:2048 lds
    s_waitcnt vmcnt(43)
    s_mov_b64 exec, 1
    ds_add_u32 v11, v12 offset:16
    s_mov_b64 exec, -1
    s_mov_b32 m0, 35072
    s_add_u32 s20, s33, 86016
    buffer_load_dwordx4 v8, s[12:15], s20 offen lds
    buffer_load_dwordx4 v9, s[12:15], s20 offen offset:1024 lds
    buffer_load_dwordx4 v10, s[12:15], s20 offen offset:2048 lds
    s_mov_b32 m0, 38144
    s_add_u32 s20, s33, 129024
    buffer_load_dwordx4 v8, s[12:15], s20 offen lds
    buffer_load_dwordx4 v9, s[12:15], s20 offen offset:1024 lds
    buffer_load_dwordx4 v10, s[12:15], s20 offen offset:2048 lds
    s_mov_b32 m0, 41216
    s_add_u32 s20, s24, 0
    buffer_load_dwordx4 v26, s[8:11], s20 offen lds
    buffer_load_dwordx4 v27, s[8:11], s20 offen offset:1024 lds
    buffer_load_dwordx4 v28, s[8:11], s20 offen offset:2048 lds
    buffer_load_dwordx4 v29, s[8:11], s20 offen offset:3072 lds
    s_mov_b32 m0, 45312
    s_add_u32 s20, s24, 28672
    buffer_load_dwordx4 v26, s[8:11], s20 offen lds
    buffer_load_dwordx4 v27, s[8:11], s20 offen offset:1024 lds
    buffer_load_dwordx4 v28, s[8:11], s20 offen offset:2048 lds
    buffer_load_dwordx4 v29, s[8:11], s20 offen offset:3072 lds
    s_mov_b32 m0, 49408
    s_add_u32 s20, s24, 57344
    buffer_load_dwordx4 v26, s[8:11], s20 offen lds
    buffer_load_dwordx4 v27, s[8:11], s20 offen offset:1024 lds
    buffer_load_dwordx4 v28, s[8:11], s20 offen offset:2048 lds
    buffer_load_dwordx4 v29, s[8:11], s20 offen offset:3072 lds
    s_mov_b32 m0, 53504
    s_add_u32 s20, s24, 86016
    buffer_load_dwordx4 v26, s[8:11], s20 offen lds
    buffer_load_dwordx4 v27, s[8:11], s20 offen offset:1024 lds
    buffer_load_dwordx4 v28, s[8:11], s20 offen offset:2048 lds
    buffer_load_dwordx4 v29, s[8:11], s20 offen offset:3072 lds
    v_bfe_u32 v14, v0, 2, 2
    v_lshrrev_b32 v15, 5, v0
    v_lshlrev_b32 v16, 6, v14
    v_lshl_add_u32 v16, v15, 9, v16
    v_and_b32 v17, 1, v0
    v_lshl_add_u32 v16, v17, 3, v16
    v_bfe_u32 v17, v0, 1, 1
    v_bfe_u32 v18, v0, 4, 1
    v_lshl_add_u32 v17, v18, 1, v17
    v_lshl_add_u32 v20, v17, 4, v16
    v_add_u32 v20, 57600, v20
    v_and_b32 v21, 31, v0
    v_lshrrev_b32 v22, 5, v0
    v_bfe_u32 v23, v0, 1, 2
    v_xor_b32 v22, v22, v23
    v_lshlrev_b32 v21, 6, v21
    v_lshl_add_u32 v21, v22, 4, v21
    v_add_u32 v21, 57600, v21
    v_xor_b32 v22, 32, v21
    v_lshlrev_b32 v23, 4, v0
    v_add_u32 v23, 57600, v23
    v_bfe_u32 v24, v0, 3, 2
    v_and_b32 v25, 3, v0
    v_xor_b32 v25, v25, v24
    v_lshrrev_b32 v24, 2, v0
    v_lshlrev_b32 v24, 12, v24
    v_lshl_add_u32 v24, v25, 4, v24
    s_waitcnt vmcnt(28)
    s_mov_b64 exec, 1
    ds_add_u32 v11, v12 offset:20
    s_mov_b64 exec, -1
    s_waitcnt vmcnt(0)
    s_mov_b64 exec, 1
    ds_add_u32 v11, v12 offset:24
    s_mov_b64 exec, -1
k1_kernel_poll_51:
    ds_read_b32 v4, v11 offset:48
    s_waitcnt lgkmcnt(0)
    v_readfirstlane_b32 s20, v4
    s_cmp_lt_u32 s20, 4
    s_cbranch_scc1 k1_kernel_poll_51
    ds_write_b128 v23, v[96:99] offset:0
    ds_write_b128 v23, v[100:103] offset:1024
    ds_write_b128 v23, v[104:107] offset:2048
    ds_write_b128 v23, v[108:111] offset:3072
    ds_write_b128 v23, v[112:115] offset:4096
    ds_write_b128 v23, v[116:119] offset:5120
    ds_write_b128 v23, v[120:123] offset:6144
    ds_write_b128 v23, v[124:127] offset:7168
    ds_read_b64_tr_b16 v[32:33], v20 offset:0
    ds_read_b64_tr_b16 v[34:35], v20 offset:256
    ds_read_b64_tr_b16 v[36:37], v20 offset:1024
    ds_read_b64_tr_b16 v[38:39], v20 offset:1280
    ds_read_b64_tr_b16 v[40:41], v20 offset:2048
    ds_read_b64_tr_b16 v[42:43], v20 offset:2304
    ds_read_b64_tr_b16 v[44:45], v20 offset:3072
    ds_read_b64_tr_b16 v[46:47], v20 offset:3328
    ds_read_b64_tr_b16 v[48:49], v20 offset:4096
    ds_read_b64_tr_b16 v[50:51], v20 offset:4352
    ds_read_b64_tr_b16 v[52:53], v20 offset:5120
    ds_read_b64_tr_b16 v[54:55], v20 offset:5376
    ds_read_b64_tr_b16 v[56:57], v20 offset:6144
    ds_read_b64_tr_b16 v[58:59], v20 offset:6400
    ds_read_b64_tr_b16 v[60:61], v20 offset:7168
    ds_read_b64_tr_b16 v[62:63], v20 offset:7424
    s_waitcnt lgkmcnt(0)
    ds_write_b128 v21, v[32:35] offset:0
    ds_write_b128 v22, v[36:39] offset:0
    ds_write_b128 v21, v[40:43] offset:2048
    ds_write_b128 v22, v[44:47] offset:2048
    ds_write_b128 v21, v[48:51] offset:4096
    ds_write_b128 v22, v[52:55] offset:4096
    ds_write_b128 v21, v[56:59] offset:6144
    ds_write_b128 v22, v[60:63] offset:6144
    ds_read_b128 v[64:67], v23 offset:0
    ds_read_b128 v[68:71], v23 offset:1024
    ds_read_b128 v[72:75], v23 offset:2048
    ds_read_b128 v[76:79], v23 offset:3072
    ds_read_b128 v[80:83], v23 offset:4096
    ds_read_b128 v[84:87], v23 offset:5120
    ds_read_b128 v[88:91], v23 offset:6144
    ds_read_b128 v[92:95], v23 offset:7168
    s_add_u32 s20, s44, 65536
    s_waitcnt lgkmcnt(6)
    buffer_store_dwordx4 v[64:67], v24, s[16:19], s44 offen sc0 sc1
    buffer_store_dwordx4 v[68:71], v24, s[16:19], s20 offen sc0 sc1
    s_add_u32 s20, s45, 65536
    s_waitcnt lgkmcnt(4)
    buffer_store_dwordx4 v[72:75], v24, s[16:19], s45 offen sc0 sc1
    buffer_store_dwordx4 v[76:79], v24, s[16:19], s20 offen sc0 sc1
    s_add_u32 s20, s46, 65536
    s_waitcnt lgkmcnt(2)
    buffer_store_dwordx4 v[80:83], v24, s[16:19], s46 offen sc0 sc1
    buffer_store_dwordx4 v[84:87], v24, s[16:19], s20 offen sc0 sc1
    s_add_u32 s20, s47, 65536
    s_waitcnt lgkmcnt(0)
    buffer_store_dwordx4 v[88:91], v24, s[16:19], s47 offen sc0 sc1
    buffer_store_dwordx4 v[92:95], v24, s[16:19], s20 offen sc0 sc1
    s_waitcnt lgkmcnt(0)
    s_mov_b32 s21, 0x8000
k1_tg:
    v_readfirstlane_b32 s20, v131
    s_cmp_ge_u32 s20, 32
    s_cbranch_scc1 k1_tg_ok
    s_sleep 8
    global_load_dword v131, v31, s[62:63] offset:128 sc1
    s_sub_u32 s21, s21, 1
    s_waitcnt vmcnt(0)
    s_cbranch_scc0 k1_tg
k1_tg_ok:
    s_waitcnt vmcnt(0) lgkmcnt(0)
    s_branch k2_ld
k1_aux:
    s_cmp_ge_u32 s2, 256
    s_cbranch_scc1 k2_end
    s_load_dwordx2 s[4:5], s[0:1], 16
    s_load_dwordx2 s[62:63], s[0:1], 104
    s_load_dwordx2 s[6:7], s[0:1], 112
    v_lshrrev_b32 v1, 6, v0
    v_and_b32 v0, 63, v0
    v_readfirstlane_b32 s3, v1
    s_sub_u32 s20, s2, 224
    s_lshr_b32 s21, s20, 1
    s_mul_i32 s21, s21, 28
    s_and_b32 s22, s20, 1
    s_lshl_b32 s23, s22, 4
    s_add_u32 s21, s21, s23
    v_lshrrev_b32 v2, 5, v0
    v_lshl_add_u32 v3, v2, 3, s21
    v_mul_u32_u24 v3, 896, v3
    v_and_b32 v4, 31, v0
    v_lshl_add_u32 v3, v4, 1, v3
    v_and_b32 v2, s22, v2
    v_lshlrev_b32 v2, 30, v2
    v_add3_u32 v4, v3, v2, 0
    v_add_u32 v4, 3584, v4
    v_lshlrev_b32 v5, 4, v0
    s_lshl_b32 s24, s3, 7
    s_add_u32 s25, s24, 64
    s_lshr_b32 s26, s3, 2
    s_lshl_b32 s26, s26, 21
    s_and_b32 s27, s3, 3
    s_lshl_b32 s27, s27, 16
    s_add_u32 s26, s26, s27
    s_lshl_b32 s27, s20, 10
    s_add_u32 s26, s26, s27
    s_add_u32 s26, s26, 12320768
    s_add_u32 s27, s26, 32768
    s_waitcnt lgkmcnt(0)
    s_mov_b32 s8, s4
    s_mov_b32 s9, s5
    s_mov_b32 s10, 401408
    s_mov_b32 s11, 0x00020000
    s_mov_b32 s12, s6
    s_mov_b32 s13, s7
    s_mov_b32 s14, 14680064
    s_mov_b32 s15, 0x00020000
    s_cmp_eq_u32 s3, 8
    s_cbranch_scc1 k1_aux8
    buffer_load_ushort v8, v3, s[8:11], s24 offen offset:0
    buffer_load_ushort v9, v3, s[8:11], s24 offen offset:896
    buffer_load_ushort v10, v3, s[8:11], s24 offen offset:1792
    buffer_load_ushort v11, v3, s[8:11], s24 offen offset:2688
    buffer_load_ushort v12, v4, s[8:11], s24 offen offset:0
    buffer_load_ushort v13, v4, s[8:11], s24 offen offset:896
    buffer_load_ushort v14, v4, s[8:11], s24 offen offset:1792
    buffer_load_ushort v15, v4, s[8:11], s24 offen offset:2688
    buffer_load_ushort v16, v3, s[8:11], s25 offen offset:0
    buffer_load_ushort v17, v3, s[8:11], s25 offen offset:896
    buffer_load_ushort v18, v3, s[8:11], s25 offen offset:1792
    buffer_load_ushort v19, v3, s[8:11], s25 offen offset:2688
    buffer_load_ushort v20, v4, s[8:11], s25 offen offset:0
    buffer_load_ushort v21, v4, s[8:11], s25 offen offset:896
    buffer_load_ushort v22, v4, s[8:11], s25 offen offset:1792
    buffer_load_ushort v23, v4, s[8:11], s25 offen offset:2688
    s_lshr_b32 s28, s20, 1
    s_lshl_b32 s28, s28, 2
    s_add_u32 s28, s28, s22
    s_lshl_b32 s28, s28, 15
    s_lshl_b32 s29, s3, 12
    s_add_u32 s28, s28, s29
    s_add_u32 s28, s28, 6356992
    v_mov_b32 v32, -1
    v_mov_b32 v33, -1
    v_mov_b32 v34, -1
    v_mov_b32 v35, -1
    s_waitcnt vmcnt(8)
    v_lshl_or_b32 v24, v9, 16, v8
    v_lshl_or_b32 v25, v11, 16, v10
    v_lshl_or_b32 v26, v13, 16, v12
    v_lshl_or_b32 v27, v15, 16, v14
    buffer_store_dwordx4 v[24:27], v5, s[12:15], s26 offen sc0 sc1
    s_waitcnt vmcnt(1)
    v_lshl_or_b32 v28, v17, 16, v16
    v_lshl_or_b32 v29, v19, 16, v18
    v_lshl_or_b32 v30, v21, 16, v20
    v_lshl_or_b32 v31, v23, 16, v22
    buffer_store_dwordx4 v[28:31], v5, s[12:15], s27 offen sc0 sc1
    buffer_store_dwordx4 v[32:35], v5, s[12:15], s28 offen sc0 sc1
    buffer_store_dwordx4 v[32:35], v5, s[12:15], s28 offen offset:1024 sc0 sc1
    buffer_store_dwordx4 v[32:35], v5, s[12:15], s28 offen offset:2048 sc0 sc1
    buffer_store_dwordx4 v[32:35], v5, s[12:15], s28 offen offset:3072 sc0 sc1
    s_waitcnt vmcnt(0)
    s_branch k2_entry
k1_aux8:
    v_lshlrev_b32 v5, 2, v0
    v_mov_b32 v6, 0
    ds_write_b32 v5, v6
    v_mov_b32 v31, 0
    v_mov_b32 v131, 0
    v_bfrev_b32 v130, 1
    s_mov_b32 s16, s12
    s_mov_b32 s17, s13
    s_mov_b32 s18, s14
    s_mov_b32 s19, s15
    s_waitcnt lgkmcnt(0)
    s_cmp_lg_u32 s2, 224
    s_cbranch_scc1 k1_aux9
    v_lshlrev_b32 v5, 7, v0
    s_mov_b32 s20, 10354688
    s_mov_b32 s21, 10362880
    buffer_store_dword v6, v5, s[12:15], s20 offen sc0 sc1
    buffer_store_dword v6, v5, s[12:15], s21 offen sc0 sc1
    s_mov_b32 s20, 10371072
    s_mov_b32 s21, 10379264
    buffer_store_dword v6, v5, s[12:15], s20 offen sc0 sc1
    buffer_store_dword v6, v5, s[12:15], s21 offen sc0 sc1
    s_waitcnt vmcnt(0)
k1_aux9:
    s_barrier
    v_mov_b32 v5, 1
    s_mov_b64 exec, 1
    global_atomic_add v131, v31, v5, s[62:63] sc0 sc1
    s_waitcnt vmcnt(0)
    v_add_u32 v131, 1, v131
    v_cmp_eq_u32 vcc, 32, v131
    s_and_b64 exec, exec, vcc
    global_store_dword v31, v131, s[62:63] offset:128 sc0 sc1
    s_mov_b64 exec, -1
    s_mov_b32 s21, 0x8000
k1_ta:
    v_readfirstlane_b32 s20, v131
    s_cmp_ge_u32 s20, 32
    s_cbranch_scc1 k1_ta_ok
    s_sleep 8
    v_mov_b32 v131, 0
    s_mov_b64 exec, 1
    global_atomic_add v131, v31, v131, s[62:63] sc0 sc1
    s_mov_b64 exec, -1
    s_sub_u32 s21, s21, 1
    s_waitcnt vmcnt(0)
    s_cbranch_scc0 k1_ta
k1_ta_ok:
    s_branch k2_ld_nb
k2_entry:
    s_barrier
k2_entry_nb:
    v_lshlrev_b32 v1, 4, v0
    s_load_dwordx2 s[24:25], s[0:1], 112
    s_load_dwordx2 s[36:37], s[0:1], 96
    s_setprio 1
    s_and_b32 s4, s2, 7
    s_lshl_b32 s4, s4, 1
    s_lshr_b32 s5, s2, 3
    s_lshr_b32 s20, s5, 4
    s_add_u32 s4, s4, s20
    s_and_b32 s5, s5, 15
    s_lshr_b32 s6, s3, 2
    s_and_b32 s7, s3, 3
    s_lshl_b32 s26, s5, 2
    s_lshl_b32 s20, s6, 1
    s_add_u32 s26, s26, s20
    s_lshl_b32 s20, s4, 6
    s_add_u32 s22, s20, s26
    s_lshl_b32 s22, s22, 11
    s_lshl_b32 s23, s7, 4
    s_add_u32 s23, s23, s20
    s_lshl_b32 s23, s23, 12
    s_add_u32 s23, s23, 2097152
    s_add_u32 s12, s23, 4096
    s_mov_b32 s10, 14680064
    s_mov_b32 s11, 0x00020000
    s_waitcnt lgkmcnt(0)
    s_mov_b32 s8, s24
    s_mov_b32 s9, s25
    s_add_u32 s13, s23, 8192
    s_add_u32 s14, s23, 12288
    s_and_b32 s27, s3, 1
    s_lshr_b32 s28, s3, 1
    s_lshl_b32 s21, s2, 1
    s_add_u32 s21, s21, s27
    s_mov_b32 s19, 0
    s_mov_b32 s33, 0
    s_mov_b32 s38, 1
    s_mov_b32 s16, 0
    s_mov_b32 s15, 1
    s_mov_b32 s17, 7
    s_mov_b32 s18, 0
    s_mov_b32 s29, 0
    s_mov_b32 s31, s28
    s_lshl_b32 s32, s28, 1
    s_cmp_lt_u32 s28, 2
    s_cbranch_scc1 k2_cfg
    s_mov_b32 s15, 1
    s_mov_b32 s17, 6
    s_mov_b32 s18, 1
    s_mov_b32 s29, 40
    s_mov_b32 s31, 1
    s_mov_b32 s32, 4
    s_cmp_eq_u32 s28, 3
    s_cbranch_scc1 k2_cfg
    s_mov_b32 s29, 28
    s_mov_b32 s17, 1
    s_mov_b32 s16, 3
    s_mov_b32 s31, 0
    s_mov_b32 s32, 1
    s_mov_b32 s18, 3
k2_cfg:
    s_cmp_lt_u32 s2, 224
    s_cbranch_scc1 k2_cfg2
    s_mov_b32 s15, 8
    s_mov_b32 s17, 0
    s_mov_b32 s16, 0
k2_cfg2:
    v_and_b32 v5, 3, v0
    v_sub_u32 v5, 3, v5
    v_mul_u32_u24 v5, 4160, v5
    v_bfe_u32 v6, v0, 2, 3
    v_lshlrev_b32 v6, 3, v6
    v_sub_u32 v5, v5, v6
    v_lshrrev_b32 v6, 5, v0
    v_lshlrev_b32 v6, 4, v6
    v_add_u32 v5, v5, v6
    s_mul_i32 s30, s27, 16640
    s_add_u32 s30, s30, 8184
    s_lshl_b32 s20, s29, 6
    s_sub_u32 s30, s30, s20
    v_add_u32 v2, s30, v5
    s_lshl_b32 s20, s31, 5
    s_add_u32 s20, s20, 28
    s_sub_u32 s20, s20, s29
    s_mul_i32 s20, s20, 80
    s_mul_i32 s30, s27, 7680
    s_add_u32 s20, s20, s30
    s_add_u32 s20, s20, 37632
    v_and_b32 v5, 31, v0
    v_mul_u32_u24 v5, 80, v5
    v_add3_u32 v3, v5, v6, s20
    v_mov_b32 v136, 0
    v_mov_b32 v137, 0
    v_mov_b32 v138, 0
    v_mov_b32 v139, 0
    v_mov_b32 v140, 0
    v_mov_b32 v141, 0
    v_mov_b32 v142, 0
    v_mov_b32 v143, 0
    v_mov_b32 v144, 0
    v_mov_b32 v145, 0
    v_mov_b32 v146, 0
    v_mov_b32 v147, 0
    v_mov_b32 v148, 0
    v_mov_b32 v149, 0
    v_mov_b32 v150, 0
    v_mov_b32 v151, 0
    s_cmp_ge_u32 s2, 224
    s_cbranch_scc1 k2_x0
    s_lshl_b32 s34, s28, 10
    s_mul_i32 s20, s21, 4224
    s_add_u32 s20, s20, 8388608
    s_add_u32 s20, s20, s34
    buffer_load_dwordx4 v[56:59], v1, s[8:11], s20 offen sc1
    buffer_load_dword v60, v1, s[8:11], s20 offen offset:16 sc1
    s_mul_i32 s20, s27, 16640
    s_add_u32 s34, s34, s20
    s_add_u32 s34, s34, 4352
    v_add_u32 v61, s34, v1
    v_add_u32 v62, 8316, v61
    v_add_u32 v63, 12476, v61
    s_cmp_lg_u32 s28, 3
    s_cbranch_scc1 k2_x0
    v_mul_u32_u24 v7, 52, v0
    v_lshrrev_b32 v7, 8, v7
    v_mul_u32_u24 v6, 5, v7
    v_sub_u32 v6, v0, v6
    v_mul_u32_u24 v7, 4160, v7
    v_lshl_add_u32 v7, v6, 4, v7
    v_add_u32 v7, s20, v7
    s_mov_b64 exec, 0xfffff
    ds_write_b128 v7, v[136:139] offset:8432
    s_mov_b64 exec, -1
k2_x0:
    s_lshl_b32 s20, s7, 2
    v_mov_b32 v5, s20
k2_go:
    s_sleep 1
    ds_read_b32 v4, v5 offset:112
    s_waitcnt lgkmcnt(0)
    v_readfirstlane_b32 s20, v4
    s_cmp_eq_u32 s20, 0
    s_cbranch_scc1 k2_go
    buffer_load_dwordx4 v[24:27], v1, s[8:11], s23 offen sc1
    buffer_load_dwordx4 v[8:11], v1, s[8:11], s22 offen sc1
    buffer_load_dwordx4 v[28:31], v1, s[8:11], s23 offen offset:1024 sc1
    buffer_load_dwordx4 v[12:15], v1, s[8:11], s22 offen offset:1024 sc1
    buffer_load_dwordx4 v[16:19], v1, s[8:11], s22 offen offset:2048 sc1
    buffer_load_dwordx4 v[20:23], v1, s[8:11], s22 offen offset:3072 sc1
    buffer_load_dwordx4 v[32:35], v1, s[8:11], s12 offen sc1
    buffer_load_dwordx4 v[36:39], v1, s[8:11], s12 offen offset:1024 sc1
    buffer_load_dwordx4 v[40:43], v1, s[8:11], s23 offen offset:2048 sc1
    buffer_load_dwordx4 v[44:47], v1, s[8:11], s23 offen offset:3072 sc1
    s_cmp_ge_u32 s2, 224
    s_cbranch_scc1 k2_restart
    s_waitcnt vmcnt(10)
    s_cmp_lg_u32 s28, 3
    s_cbranch_scc1 k2_x1
    v_writelane_b32 v60, 0, 63
k2_x1:
    ds_write_b128 v61, v[56:59]
    v_alignbit_b32 v64, v57, v56, 16
    v_alignbit_b32 v65, v58, v57, 16
    v_alignbit_b32 v66, v59, v58, 16
    ds_write2_b32 v62, v56, v57 offset0:0 offset1:1
    ds_write2_b32 v62, v58, v59 offset0:2 offset1:3
    v_alignbit_b32 v67, v60, v59, 16
    v_mov_b32 v6, 0
    v_mov_b32 v7, 1
    ds_write_b128 v61, v[64:67] offset:4160
    ds_write2_b32 v63, v64, v65 offset0:0 offset1:1
    ds_write2_b32 v63, v66, v67 offset0:2 offset1:3
    s_mov_b64 exec, 1
    ds_add_u32 v6, v7 offset:0
    s_mov_b64 exec, -1
k2_restart:
    v_mov_b32 v104, 0
    v_mov_b32 v105, 0
    v_mov_b32 v106, 0
    v_mov_b32 v107, 0
    v_mov_b32 v108, 0
    v_mov_b32 v109, 0
    v_mov_b32 v110, 0
    v_mov_b32 v111, 0
    v_mov_b32 v112, 0
    v_mov_b32 v113, 0
    v_mov_b32 v114, 0
    v_mov_b32 v115, 0
    v_mov_b32 v116, 0
    v_mov_b32 v117, 0
    v_mov_b32 v118, 0
    v_mov_b32 v119, 0
    v_mov_b32 v120, 0
    v_mov_b32 v121, 0
    v_mov_b32 v122, 0
    v_mov_b32 v123, 0
    v_mov_b32 v124, 0
    v_mov_b32 v125, 0
    v_mov_b32 v126, 0
    v_mov_b32 v127, 0
    v_mov_b32 v128, 0
    v_mov_b32 v129, 0
    v_mov_b32 v130, 0
    v_mov_b32 v131, 0
    v_mov_b32 v132, 0
    v_mov_b32 v133, 0
    v_mov_b32 v134, 0
    v_mov_b32 v135, 0
    v_mov_b32 v96, 0
    v_mov_b32 v97, 0
    v_mov_b32 v98, 0
    v_mov_b32 v99, 0
    v_mov_b32 v100, 0
    v_mov_b32 v101, 0
    v_mov_b32 v102, 0
    v_mov_b32 v103, 0
    v_mov_b32 v48, 0
    v_mov_b32 v49, 0
    v_mov_b32 v50, 0
    v_mov_b32 v51, 0
    v_mov_b32 v52, 0
    v_mov_b32 v53, 0
    v_mov_b32 v54, 0
    v_mov_b32 v55, 0
    s_waitcnt vmcnt(6)
    v_mfma_f32_32x32x16_bf16 v[56:71], v[24:27], v[8:11], 0
    v_mfma_f32_32x32x16_bf16 v[56:71], v[28:31], v[12:15], v[56:71]
    s_waitcnt vmcnt(4)
    s_cmp_lg_u32 s3, 0
    s_cbranch_scc1 k2_nosig
    v_mov_b32 v5, 0
    v_mov_b32 v6, 1
    s_mov_b64 exec, 1
    ds_add_u32 v5, v6 offset:8
    s_mov_b64 exec, -1
k2_nosig:
    s_nop 7
    s_nop 3
k2_plain:
    s_cmp_eq_u32 s15, 0
    s_cbranch_scc1 k2_plain_done
    .p2align 6
k2_lp:
    v_mfma_f32_32x32x16_bf16 v[72:87], v[24:27], v[16:19], 0
    v_exp_f32 v56, v56
    v_exp_f32 v57, v57
    v_exp_f32 v58, v58
    v_exp_f32 v59, v59
    v_cvt_pk_bf16_f32 v88, v56, v57
    v_cvt_pk_bf16_f32 v89, v58, v59
    v_mfma_f32_32x32x16_bf16 v[120:135], v[48:51], v[96:99], v[120:135]
    v_exp_f32 v60, v60
    v_exp_f32 v61, v61
    v_exp_f32 v62, v62
    v_exp_f32 v63, v63
    v_cvt_pk_bf16_f32 v90, v60, v61
    v_cvt_pk_bf16_f32 v91, v62, v63
    v_mfma_f32_32x32x16_bf16 v[72:87], v[28:31], v[20:23], v[72:87]
    buffer_load_dwordx4 v[24:27], v1, s[8:11], s13 offen sc1
    buffer_load_dwordx4 v[28:31], v1, s[8:11], s13 offen offset:1024 sc1
    v_exp_f32 v64, v64
    v_exp_f32 v65, v65
    v_exp_f32 v66, v66
    v_exp_f32 v67, v67
    v_cvt_pk_bf16_f32 v92, v64, v65
    v_cvt_pk_bf16_f32 v93, v66, v67
    v_mfma_f32_32x32x16_bf16 v[120:135], v[52:55], v[100:103], v[120:135]
    buffer_load_dwordx4 v[48:51], v1, s[8:11], s12 offen offset:2048 sc1
    buffer_load_dwordx4 v[52:55], v1, s[8:11], s12 offen offset:3072 sc1
    v_exp_f32 v68, v68
    v_exp_f32 v69, v69
    v_exp_f32 v70, v70
    v_exp_f32 v71, v71
    v_cvt_pk_bf16_f32 v94, v68, v69
    v_cvt_pk_bf16_f32 v95, v70, v71
    s_waitcnt vmcnt(4)
    v_mfma_f32_32x32x16_bf16 v[56:71], v[32:35], v[8:11], 0
    v_exp_f32 v72, v72
    v_exp_f32 v73, v73
    v_exp_f32 v74, v74
    v_exp_f32 v75, v75
    v_cvt_pk_bf16_f32 v96, v72, v73
    v_cvt_pk_bf16_f32 v97, v74, v75
    v_mfma_f32_32x32x16_bf16 v[104:119], v[40:43], v[88:91], v[104:119]
    v_exp_f32 v76, v76
    v_exp_f32 v77, v77
    v_exp_f32 v78, v78
    v_exp_f32 v79, v79
    v_cvt_pk_bf16_f32 v98, v76, v77
    v_cvt_pk_bf16_f32 v99, v78, v79
    v_mfma_f32_32x32x16_bf16 v[56:71], v[36:39], v[12:15], v[56:71]
    v_exp_f32 v80, v80
    v_exp_f32 v81, v81
    v_exp_f32 v82, v82
    v_exp_f32 v83, v83
    v_cvt_pk_bf16_f32 v100, v80, v81
    v_cvt_pk_bf16_f32 v101, v82, v83
    v_mfma_f32_32x32x16_bf16 v[104:119], v[44:47], v[92:95], v[104:119]
    v_exp_f32 v84, v84
    v_exp_f32 v85, v85
    v_exp_f32 v86, v86
    v_exp_f32 v87, v87
    v_cvt_pk_bf16_f32 v102, v84, v85
    v_cvt_pk_bf16_f32 v103, v86, v87
    v_mfma_f32_32x32x16_bf16 v[72:87], v[32:35], v[16:19], 0
    v_exp_f32 v56, v56
    v_exp_f32 v57, v57
    v_exp_f32 v58, v58
    v_exp_f32 v59, v59
    v_cvt_pk_bf16_f32 v88, v56, v57
    v_cvt_pk_bf16_f32 v89, v58, v59
    v_mfma_f32_32x32x16_bf16 v[120:135], v[40:43], v[96:99], v[120:135]
    v_exp_f32 v60, v60
    v_exp_f32 v61, v61
    v_exp_f32 v62, v62
    v_exp_f32 v63, v63
    v_cvt_pk_bf16_f32 v90, v60, v61
    v_cvt_pk_bf16_f32 v91, v62, v63
    v_mfma_f32_32x32x16_bf16 v[72:87], v[36:39], v[20:23], v[72:87]
    buffer_load_dwordx4 v[32:35], v1, s[8:11], s14 offen sc1
    buffer_load_dwordx4 v[36:39], v1, s[8:11], s14 offen offset:1024 sc1
    v_exp_f32 v64, v64
    v_exp_f32 v65, v65
    v_exp_f32 v66, v66
    v_exp_f32 v67, v67
    v_cvt_pk_bf16_f32 v92, v64, v65
    v_cvt_pk_bf16_f32 v93, v66, v67
    v_mfma_f32_32x32x16_bf16 v[120:135], v[44:47], v[100:103], v[120:135]
    buffer_load_dwordx4 v[40:43], v1, s[8:11], s13 offen offset:2048 sc1
    buffer_load_dwordx4 v[44:47], v1, s[8:11], s13 offen offset:3072 sc1
    v_exp_f32 v68, v68
    v_exp_f32 v69, v69
    v_exp_f32 v70, v70
    v_exp_f32 v71, v71
    v_cvt_pk_bf16_f32 v94, v68, v69
    v_cvt_pk_bf16_f32 v95, v70, v71
    s_waitcnt vmcnt(4)
    v_mfma_f32_32x32x16_bf16 v[56:71], v[24:27], v[8:11], 0
    v_exp_f32 v72, v72
    v_exp_f32 v73, v73
    v_exp_f32 v74, v74
    v_exp_f32 v75, v75
    v_cvt_pk_bf16_f32 v96, v72, v73
    v_cvt_pk_bf16_f32 v97, v74, v75
    v_mfma_f32_32x32x16_bf16 v[104:119], v[48:51], v[88:91], v[104:119]
    v_exp_f32 v76, v76
    v_exp_f32 v77, v77
    v_exp_f32 v78, v78
    v_exp_f32 v79, v79
    v_cvt_pk_bf16_f32 v98, v76, v77
    v_cvt_pk_bf16_f32 v99, v78, v79
    v_mfma_f32_32x32x16_bf16 v[56:71], v[28:31], v[12:15], v[56:71]
    v_exp_f32 v80, v80
    v_exp_f32 v81, v81
    v_exp_f32 v82, v82
    v_exp_f32 v83, v83
    v_cvt_pk_bf16_f32 v100, v80, v81
    v_cvt_pk_bf16_f32 v101, v82, v83
    v_mfma_f32_32x32x16_bf16 v[104:119], v[52:55], v[92:95], v[104:119]
    v_exp_f32 v84, v84
    v_exp_f32 v85, v85
    v_exp_f32 v86, v86
    v_exp_f32 v87, v87
    v_cvt_pk_bf16_f32 v102, v84, v85
    v_cvt_pk_bf16_f32 v103, v86, v87
    s_add_u32 s12, s12, 8192
    s_add_u32 s13, s13, 8192
    s_add_u32 s14, s14, 8192
    s_sub_u32 s15, s15, 1
    s_cmp_lg_u32 s15, 0
    s_cbranch_scc1 k2_lp
k2_plain_done:
    s_cmp_eq_u32 s17, 0
    s_cbranch_scc1 k2_tail
    v_mov_b32 v5, 0
k1_kernel_poll_52:
    ds_read_b32 v4, v5 offset:0
    s_waitcnt lgkmcnt(0)
    v_readfirstlane_b32 s20, v4
    s_cmp_lt_u32 s20, 9
    s_cbranch_scc1 k1_kernel_poll_52
k2_cseg:
    ds_read2_b64 v[152:155], v2 offset0:32 offset1:33
    ds_read_b128 v[160:163], v3 offset:320
    ds_read2_b64 v[156:159], v2 offset0:36 offset1:37
    ds_read_b128 v[164:167], v3 offset:352
    .p2align 6
k2_lc:
    v_mfma_f32_32x32x16_bf16 v[72:87], v[24:27], v[16:19], 0
    v_exp_f32 v56, v56
    v_exp_f32 v57, v57
    v_exp_f32 v58, v58
    v_cvt_pk_bf16_f32 v88, v56, v57
    s_waitcnt lgkmcnt(2)
    v_mfma_f32_32x32x16_bf16 v[136:151], v[152:155], v[160:163], v[136:151]
    ds_read2_b64 v[152:155], v2 offset0:24 offset1:25
    ds_read_b128 v[160:163], v3 offset:240
    v_exp_f32 v59, v59
    v_exp_f32 v60, v60
    v_exp_f32 v61, v61
    v_cvt_pk_bf16_f32 v89, v58, v59
    v_mfma_f32_32x32x16_bf16 v[120:135], v[48:51], v[96:99], v[120:135]
    v_exp_f32 v62, v62
    v_exp_f32 v63, v63
    v_cvt_pk_bf16_f32 v90, v60, v61
    v_cvt_pk_bf16_f32 v91, v62, v63
    v_mfma_f32_32x32x16_bf16 v[72:87], v[28:31], v[20:23], v[72:87]
    buffer_load_dwordx4 v[24:27], v1, s[8:11], s13 offen sc1
    buffer_load_dwordx4 v[28:31], v1, s[8:11], s13 offen offset:1024 sc1
    v_exp_f32 v64, v64
    v_exp_f32 v65, v65
    v_exp_f32 v66, v66
    v_cvt_pk_bf16_f32 v92, v64, v65
    s_waitcnt lgkmcnt(2)
    v_mfma_f32_32x32x16_bf16 v[136:151], v[156:159], v[164:167], v[136:151]
    ds_read2_b64 v[156:159], v2 offset0:28 offset1:29
    ds_read_b128 v[164:167], v3 offset:272
    v_exp_f32 v67, v67
    v_exp_f32 v68, v68
    v_exp_f32 v69, v69
    v_cvt_pk_bf16_f32 v93, v66, v67
    v_mfma_f32_32x32x16_bf16 v[120:135], v[52:55], v[100:103], v[120:135]
    buffer_load_dwordx4 v[48:51], v1, s[8:11], s12 offen offset:2048 sc1
    buffer_load_dwordx4 v[52:55], v1, s[8:11], s12 offen offset:3072 sc1
    v_exp_f32 v70, v70
    v_exp_f32 v71, v71
    v_cvt_pk_bf16_f32 v94, v68, v69
    v_cvt_pk_bf16_f32 v95, v70, v71
    s_waitcnt vmcnt(4)
    v_mfma_f32_32x32x16_bf16 v[56:71], v[32:35], v[8:11], 0
    v_exp_f32 v72, v72
    v_exp_f32 v73, v73
    v_exp_f32 v74, v74
    v_cvt_pk_bf16_f32 v96, v72, v73
    s_waitcnt lgkmcnt(2)
    v_mfma_f32_32x32x16_bf16 v[136:151], v[152:155], v[160:163], v[136:151]
    ds_read2_b64 v[152:155], v2 offset0:16 offset1:17
    ds_read_b128 v[160:163], v3 offset:160
    v_exp_f32 v75, v75
    v_exp_f32 v76, v76
    v_exp_f32 v77, v77
    v_cvt_pk_bf16_f32 v97, v74, v75
    v_mfma_f32_32x32x16_bf16 v[104:119], v[40:43], v[88:91], v[104:119]
    v_exp_f32 v78, v78
    v_exp_f32 v79, v79
    v_cvt_pk_bf16_f32 v98, v76, v77
    v_cvt_pk_bf16_f32 v99, v78, v79
    v_mfma_f32_32x32x16_bf16 v[56:71], v[36:39], v[12:15], v[56:71]
    v_exp_f32 v80, v80
    v_exp_f32 v81, v81
    v_exp_f32 v82, v82
    v_cvt_pk_bf16_f32 v100, v80, v81
    s_waitcnt lgkmcnt(2)
    v_mfma_f32_32x32x16_bf16 v[136:151], v[156:159], v[164:167], v[136:151]
    ds_read2_b64 v[156:159], v2 offset0:20 offset1:21
    ds_read_b128 v[164:167], v3 offset:192
    v_exp_f32 v83, v83
    v_exp_f32 v84, v84
    v_exp_f32 v85, v85
    v_cvt_pk_bf16_f32 v101, v82, v83
    v_mfma_f32_32x32x16_bf16 v[104:119], v[44:47], v[92:95], v[104:119]
    v_exp_f32 v86, v86
    v_exp_f32 v87, v87
    v_cvt_pk_bf16_f32 v102, v84, v85
    v_cvt_pk_bf16_f32 v103, v86, v87
    v_mfma_f32_32x32x16_bf16 v[72:87], v[32:35], v[16:19], 0
    v_exp_f32 v56, v56
    v_exp_f32 v57, v57
    v_exp_f32 v58, v58
    v_cvt_pk_bf16_f32 v88, v56, v57
    s_waitcnt lgkmcnt(2)
    v_mfma_f32_32x32x16_bf16 v[136:151], v[152:155], v[160:163], v[136:151]
    ds_read2_b64 v[152:155], v2 offset0:8 offset1:9
    ds_read_b128 v[160:163], v3 offset:80
    v_exp_f32 v59, v59
    v_exp_f32 v60, v60
    v_exp_f32 v61, v61
    v_cvt_pk_bf16_f32 v89, v58, v59
    v_mfma_f32_32x32x16_bf16 v[120:135], v[40:43], v[96:99], v[120:135]
    v_exp_f32 v62, v62
    v_exp_f32 v63, v63
    v_cvt_pk_bf16_f32 v90, v60, v61
    v_cvt_pk_bf16_f32 v91, v62, v63
    v_mfma_f32_32x32x16_bf16 v[72:87], v[36:39], v[20:23], v[72:87]
    buffer_load_dwordx4 v[32:35], v1, s[8:11], s14 offen sc1
    buffer_load_dwordx4 v[36:39], v1, s[8:11], s14 offen offset:1024 sc1
    v_exp_f32 v64, v64
    v_exp_f32 v65, v65
    v_exp_f32 v66, v66
    v_cvt_pk_bf16_f32 v92, v64, v65
    s_waitcnt lgkmcnt(2)
    v_mfma_f32_32x32x16_bf16 v[136:151], v[156:159], v[164:167], v[136:151]
    ds_read2_b64 v[156:159], v2 offset0:12 offset1:13
    ds_read_b128 v[164:167], v3 offset:112
    v_exp_f32 v67, v67
    v_exp_f32 v68, v68
    v_exp_f32 v69, v69
    v_cvt_pk_bf16_f32 v93, v66, v67
    v_mfma_f32_32x32x16_bf16 v[120:135], v[44:47], v[100:103], v[120:135]
    buffer_load_dwordx4 v[40:43], v1, s[8:11], s13 offen offset:2048 sc1
    buffer_load_dwordx4 v[44:47], v1, s[8:11], s13 offen offset:3072 sc1
    v_exp_f32 v70, v70
    v_exp_f32 v71, v71
    v_cvt_pk_bf16_f32 v94, v68, v69
    v_cvt_pk_bf16_f32 v95, v70, v71
    s_waitcnt vmcnt(4)
    v_mfma_f32_32x32x16_bf16 v[56:71], v[24:27], v[8:11], 0
    v_exp_f32 v72, v72
    v_exp_f32 v73, v73
    v_exp_f32 v74, v74
    v_cvt_pk_bf16_f32 v96, v72, v73
    s_waitcnt lgkmcnt(2)
    v_mfma_f32_32x32x16_bf16 v[136:151], v[152:155], v[160:163], v[136:151]
    ds_read2_b64 v[152:155], v2 offset0:0 offset1:1
    ds_read_b128 v[160:163], v3 offset:0
    v_exp_f32 v75, v75
    v_exp_f32 v76, v76
    v_exp_f32 v77, v77
    v_cvt_pk_bf16_f32 v97, v74, v75
    v_mfma_f32_32x32x16_bf16 v[104:119], v[48:51], v[88:91], v[104:119]
    v_exp_f32 v78, v78
    v_exp_f32 v79, v79
    v_cvt_pk_bf16_f32 v98, v76, v77
    v_cvt_pk_bf16_f32 v99, v78, v79
    v_mfma_f32_32x32x16_bf16 v[56:71], v[28:31], v[12:15], v[56:71]
    v_exp_f32 v80, v80
    v_exp_f32 v81, v81
    v_exp_f32 v82, v82
    v_cvt_pk_bf16_f32 v100, v80, v81
    s_waitcnt lgkmcnt(2)
    v_mfma_f32_32x32x16_bf16 v[136:151], v[156:159], v[164:167], v[136:151]
    ds_read2_b64 v[156:159], v2 offset0:4 offset1:5
    ds_read_b128 v[164:167], v3 offset:32
    v_exp_f32 v83, v83
    v_exp_f32 v84, v84
    v_exp_f32 v85, v85
    v_cvt_pk_bf16_f32 v101, v82, v83
    v_mfma_f32_32x32x16_bf16 v[104:119], v[52:55], v[92:95], v[104:119]
    v_exp_f32 v86, v86
    v_exp_f32 v87, v87
    v_cvt_pk_bf16_f32 v102, v84, v85
    v_cvt_pk_bf16_f32 v103, v86, v87
    s_add_u32 s12, s12, 8192
    s_add_u32 s13, s13, 8192
    s_add_u32 s14, s14, 8192
    v_subrev_u32 v2, 256, v2
    v_subrev_u32 v3, 320, v3
    s_sub_u32 s17, s17, 1
    s_cmp_lg_u32 s17, 0
    s_cbranch_scc1 k2_lc
    s_mul_i32 s29, s27, 21760
    s_add_u32 s29, s29, 52992
    s_mul_i32 s20, s32, 4352
    s_add_u32 s20, s20, s29
    v_add_u32 v6, s20, v1
    s_lshl_b32 s20, s27, 1
    s_add_u32 s20, s20, s31
    s_lshl_b32 s20, s20, 2
    v_mov_b32 v5, s20
    v_mov_b32 v7, 1
    ds_write_b128 v6, v[136:139] offset:0
    ds_write_b128 v6, v[140:143] offset:1088
    ds_write_b128 v6, v[144:147] offset:2176
    ds_write_b128 v6, v[148:151] offset:3264
    s_mov_b64 exec, 1
    ds_add_rtn_u32 v7, v5, v7 offset:64
    s_mov_b64 exec, -1
    s_add_u32 s30, s31, 1
    s_waitcnt lgkmcnt(0)
    v_readfirstlane_b32 s20, v7
    s_cmp_eq_u32 s20, s30
    s_cbranch_scc0 k2_cnext
    s_mul_i32 s20, s31, 8704
    s_add_u32 s20, s20, s29
    v_and_b32 v6, 3, v0
    v_mul_u32_u24 v6, 1088, v6
    v_lshrrev_b32 v7, 2, v0
    v_lshlrev_b32 v7, 4, v7
    v_add3_u32 v6, v6, v7, s20
    ds_read_b128 v[136:139], v6 offset:0
    ds_read_b128 v[140:143], v6 offset:512
    ds_read_b128 v[144:147], v6 offset:256
    ds_read_b128 v[148:151], v6 offset:768
    ds_read_b128 v[152:155], v6 offset:4352
    ds_read_b128 v[156:159], v6 offset:4864
    ds_read_b128 v[160:163], v6 offset:4608
    ds_read_b128 v[164:167], v6 offset:5120
    s_waitcnt lgkmcnt(0)
    v_add_f32 v136, v136, v152
    v_add_f32 v137, v137, v153
    v_add_f32 v138, v138, v154
    v_add_f32 v139, v139, v155
    v_add_f32 v140, v140, v156
    v_add_f32 v141, v141, v157
    v_add_f32 v142, v142, v158
    v_add_f32 v143, v143, v159
    v_add_f32 v144, v144, v160
    v_add_f32 v145, v145, v161
    v_add_f32 v146, v146, v162
    v_add_f32 v147, v147, v163
    v_add_f32 v148, v148, v164
    v_add_f32 v149, v149, v165
    v_add_f32 v150, v150, v166
    v_add_f32 v151, v151, v167
    s_cmp_eq_u32 s31, 0
    s_cbranch_scc1 k2_cpack
    ds_read_b128 v[152:155], v6 offset:8704
    ds_read_b128 v[156:159], v6 offset:9216
    ds_read_b128 v[160:163], v6 offset:8960
    ds_read_b128 v[164:167], v6 offset:9472
    s_waitcnt lgkmcnt(0)
    v_add_f32 v136, v136, v152
    v_add_f32 v137, v137, v153
    v_add_f32 v138, v138, v154
    v_add_f32 v139, v139, v155
    v_add_f32 v140, v140, v156
    v_add_f32 v141, v141, v157
    v_add_f32 v142, v142, v158
    v_add_f32 v143, v143, v159
    v_add_f32 v144, v144, v160
    v_add_f32 v145, v145, v161
    v_add_f32 v146, v146, v162
    v_add_f32 v147, v147, v163
    v_add_f32 v148, v148, v164
    v_add_f32 v149, v149, v165
    v_add_f32 v150, v150, v166
    v_add_f32 v151, v151, v167
k2_cpack:
    s_waitcnt lgkmcnt(0)
    v_cvt_pk_bf16_f32 v152, v136, v137
    v_cvt_pk_bf16_f32 v153, v138, v139
    v_cvt_pk_bf16_f32 v154, v140, v141
    v_cvt_pk_bf16_f32 v155, v142, v143
    v_cvt_pk_bf16_f32 v156, v144, v145
    v_cvt_pk_bf16_f32 v157, v146, v147
    v_cvt_pk_bf16_f32 v158, v148, v149
    v_cvt_pk_bf16_f32 v159, v150, v151
    s_lshl_b32 s34, s21, 12
    s_lshl_b32 s20, s31, 11
    s_add_u32 s34, s34, s20
    s_add_u32 s34, s34, 12582912
    s_mov_b32 s33, 1
    s_lshl_b32 s20, 2, s31
    s_or_b32 s38, s38, s20
k2_cnext:
    s_mov_b32 s15, s18
    s_cmp_eq_u32 s16, 0
    s_cbranch_scc1 k2_plain
    s_cmp_eq_u32 s33, 0
    s_cbranch_scc1 k2_cn2
    buffer_store_dwordx4 v[152:155], v1, s[8:11], s34 offen sc0 sc1
    buffer_store_dwordx4 v[156:159], v1, s[8:11], s34 offen offset:1024 sc0 sc1
    s_mov_b32 s33, 0
k2_cn2:
    v_mov_b32 v136, 0
    v_mov_b32 v137, 0
    v_mov_b32 v138, 0
    v_mov_b32 v139, 0
    v_mov_b32 v140, 0
    v_mov_b32 v141, 0
    v_mov_b32 v142, 0
    v_mov_b32 v143, 0
    v_mov_b32 v144, 0
    v_mov_b32 v145, 0
    v_mov_b32 v146, 0
    v_mov_b32 v147, 0
    v_mov_b32 v148, 0
    v_mov_b32 v149, 0
    v_mov_b32 v150, 0
    v_mov_b32 v151, 0
    v_add_u32 v2, 256, v2
    v_add_u32 v3, 2880, v3
    s_mov_b32 s17, s16
    s_mov_b32 s16, 0
    s_mov_b32 s31, 1
    s_mov_b32 s32, 3
    s_branch k2_cseg
k2_tail:
    v_mfma_f32_32x32x16_bf16 v[120:135], v[48:51], v[96:99], v[120:135]
    v_mfma_f32_32x32x16_bf16 v[120:135], v[52:55], v[100:103], v[120:135]
    s_cmp_eq_u32 s33, 0
    s_cbranch_scc1 k2_noy
    buffer_store_dwordx4 v[152:155], v1, s[8:11], s34 offen sc0 sc1
    buffer_store_dwordx4 v[156:159], v1, s[8:11], s34 offen offset:1024 sc0 sc1
    s_mov_b32 s33, 0
k2_noy:
    v_mov_b32 v161, 1
    v_and_b32 v5, 31, v0
    v_lshlrev_b32 v5, 4, v5
    s_lshl_b32 s20, s6, 10
    s_add_u32 s20, s20, 256
    v_add_u32 v5, s20, v5
    s_lshl_b32 s20, s7, 2
    v_add_u32 v6, s20, v5
    s_mul_i32 s20, s6, 33792
    s_add_u32 s20, s20, 96512
    v_add_u32 v7, s20, v1
    s_lshl_b32 s29, s19, 4
    s_lshl_b32 s20, s6, 2
    s_add_u32 s20, s20, s29
    v_mov_b32 v160, s20
    s_lshr_b32 s20, s7, 1
    s_add_u32 s29, s26, s20
    s_lshr_b32 s20, s2, 4
    s_lshl_b32 s20, s20, 8
    s_add_u32 s20, s20, 8192-128
    v_lshl_add_u32 v162, v0, 7, s20
    s_lshl_b32 s20, s29, 7
    v_writelane_b32 v162, s20, 0
    s_lshl_b32 s29, s29, 15
    s_add_u32 s29, s29, 6291456
    s_lshl_b32 s30, s4, 11
    s_add_u32 s29, s29, s30
    s_and_b32 s20, s7, 1
    s_lshl_b32 s20, s20, 10
    s_add_u32 s29, s29, s20
    s_mov_b32 s35, 10354688
    s_mov_b32 exec_lo, 0
    ds_write_b32 v6, v116
    s_mov_b32 exec_lo, -1
    s_cmp_eq_u32 s7, 1
    s_cbranch_scc1 k2_cmb1
    s_cmp_eq_u32 s7, 2
    s_cbranch_scc1 k2_cmb2
    s_cmp_eq_u32 s7, 3
    s_cbranch_scc1 k2_cmb3
k2_cmb0:
    ds_write_b128 v7, v[112:115] offset:8448
    ds_write_b128 v7, v[116:119] offset:9472
    s_mov_b32 exec_lo, 0
    ds_write_b32 v6, v132 offset:512
    s_mov_b32 exec_lo, -1
    ds_write_b128 v7, v[120:123] offset:16896
    ds_write_b128 v7, v[124:127] offset:17920
    ds_write_b128 v7, v[128:131] offset:25344
    ds_write_b128 v7, v[132:135] offset:26368
    s_mov_b64 exec, 1
    ds_add_u32 v160, v161 offset:16
    s_mov_b64 exec, -1
k1_kernel_poll_53:
    ds_read_b32 v4, v160 offset:16
    s_waitcnt lgkmcnt(0)
    v_readfirstlane_b32 s20, v4
    s_cmp_lt_u32 s20, 4
    s_cbranch_scc1 k1_kernel_poll_53
    s_mov_b32 exec_hi, 0
    s_andn2_b32 exec_lo, s6, s7
    buffer_atomic_add v161, v162, s[8:11], s35 offen sc1
    s_mov_b64 exec, -1
    ds_read_b128 v[88:91], v5
    ds_read_b128 v[92:95], v5 offset:512
    ds_read_b128 v[56:59], v7 offset:0
    ds_read_b128 v[60:63], v7 offset:1024
    ds_read_b128 v[64:67], v7 offset:2048
    ds_read_b128 v[68:71], v7 offset:3072
    ds_read_b128 v[72:75], v7 offset:4096
    ds_read_b128 v[76:79], v7 offset:5120
    s_waitcnt lgkmcnt(6)
    v_add_f32 v88, v88, v89
    v_add_f32 v90, v90, v91
    v_add_f32 v88, v88, v90
    v_add_f32 v92, v92, v93
    v_add_f32 v94, v94, v95
    v_add_f32 v92, v92, v94
    v_rcp_f32 v89, v88
    v_min_f32 v90, v88, v92
    v_add_f32 v93, v88, v92
    s_mov_b32 s20, 0x2b800000
    v_cmp_le_f32 vcc, s20, v90
    s_mov_b32 s20, 0x53800000
    v_cmp_ge_f32 s[30:31], s20, v93
    s_and_b64 vcc, vcc, s[30:31]
    s_cmp_eq_u64 vcc, -1
    s_cselect_b32 s20, 1, s19
    s_cmp_eq_u32 s20, 0
    s_cbranch_scc1 k2_fallback
    s_waitcnt lgkmcnt(4)
    v_add_f32 v104, v104, v56
    v_add_f32 v105, v105, v57
    v_add_f32 v106, v106, v58
    v_add_f32 v107, v107, v59
    v_add_f32 v108, v108, v60
    v_add_f32 v109, v109, v61
    v_add_f32 v110, v110, v62
    v_add_f32 v111, v111, v63
    s_waitcnt lgkmcnt(2)
    v_add_f32 v104, v104, v64
    v_add_f32 v105, v105, v65
    v_add_f32 v106, v106, v66
    v_add_f32 v107, v107, v67
    v_add_f32 v108, v108, v68
    v_add_f32 v109, v109, v69
    v_add_f32 v110, v110, v70
    v_add_f32 v111, v111, v71
    s_waitcnt lgkmcnt(0)
    v_add_f32 v104, v104, v72
    v_add_f32 v105, v105, v73
    v_add_f32 v106, v106, v74
    v_add_f32 v107, v107, v75
    v_add_f32 v108, v108, v76
    v_add_f32 v109, v109, v77
    v_add_f32 v110, v110, v78
    v_add_f32 v111, v111, v79
    v_mul_f32 v104, v104, v89
    v_mul_f32 v105, v105, v89
    v_mul_f32 v106, v106, v89
    v_mul_f32 v107, v107, v89
    v_mul_f32 v108, v108, v89
    v_mul_f32 v109, v109, v89
    v_mul_f32 v110, v110, v89
    v_mul_f32 v111, v111, v89
    v_cvt_pk_bf16_f32 v56, v104, v105
    v_cvt_pk_bf16_f32 v57, v106, v107
    v_cvt_pk_bf16_f32 v58, v108, v109
    v_cvt_pk_bf16_f32 v59, v110, v111
    s_nop 0
    v_permlane32_swap_b32 v56, v58
    v_permlane32_swap_b32 v57, v59
    buffer_store_dwordx4 v[56:59], v1, s[8:11], s29 offen sc0 sc1
    s_branch k2_post
k2_cmb1:
    ds_write_b128 v7, v[104:107] offset:0
    ds_write_b128 v7, v[108:111] offset:1024
    s_mov_b32 exec_lo, 0
    ds_write_b32 v6, v132 offset:512
    s_mov_b32 exec_lo, -1
    ds_write_b128 v7, v[120:123] offset:18944
    ds_write_b128 v7, v[124:127] offset:19968
    ds_write_b128 v7, v[128:131] offset:27392
    ds_write_b128 v7, v[132:135] offset:28416
    s_mov_b64 exec, 1
    ds_add_u32 v160, v161 offset:16
    s_mov_b64 exec, -1
k1_kernel_poll_54:
    ds_read_b32 v4, v160 offset:16
    s_waitcnt lgkmcnt(0)
    v_readfirstlane_b32 s20, v4
    s_cmp_lt_u32 s20, 4
    s_cbranch_scc1 k1_kernel_poll_54
    s_mov_b32 exec_hi, 0
    s_andn2_b32 exec_lo, s6, s7
    buffer_atomic_add v161, v162, s[8:11], s35 offen sc1
    s_mov_b64 exec, -1
    ds_read_b128 v[88:91], v5
    ds_read_b128 v[92:95], v5 offset:512
    ds_read_b128 v[56:59], v7 offset:8448
    ds_read_b128 v[60:63], v7 offset:9472
    ds_read_b128 v[64:67], v7 offset:10496
    ds_read_b128 v[68:71], v7 offset:11520
    ds_read_b128 v[72:75], v7 offset:12544
    ds_read_b128 v[76:79], v7 offset:13568
    s_waitcnt lgkmcnt(6)
    v_add_f32 v88, v88, v89
    v_add_f32 v90, v90, v91
    v_add_f32 v88, v88, v90
    v_add_f32 v92, v92, v93
    v_add_f32 v94, v94, v95
    v_add_f32 v92, v92, v94
    v_rcp_f32 v89, v88
    v_min_f32 v90, v88, v92
    v_add_f32 v93, v88, v92
    s_mov_b32 s20, 0x2b800000
    v_cmp_le_f32 vcc, s20, v90
    s_mov_b32 s20, 0x53800000
    v_cmp_ge_f32 s[30:31], s20, v93
    s_and_b64 vcc, vcc, s[30:31]
    s_cmp_eq_u64 vcc, -1
    s_cselect_b32 s20, 1, s19
    s_cmp_eq_u32 s20, 0
    s_cbranch_scc1 k2_fallback
    s_waitcnt lgkmcnt(4)
    v_add_f32 v112, v112, v56
    v_add_f32 v113, v113, v57
    v_add_f32 v114, v114, v58
    v_add_f32 v115, v115, v59
    v_add_f32 v116, v116, v60
    v_add_f32 v117, v117, v61
    v_add_f32 v118, v118, v62
    v_add_f32 v119, v119, v63
    s_waitcnt lgkmcnt(2)
    v_add_f32 v112, v112, v64
    v_add_f32 v113, v113, v65
    v_add_f32 v114, v114, v66
    v_add_f32 v115, v115, v67
    v_add_f32 v116, v116, v68
    v_add_f32 v117, v117, v69
    v_add_f32 v118, v118, v70
    v_add_f32 v119, v119, v71
    s_waitcnt lgkmcnt(0)
    v_add_f32 v112, v112, v72
    v_add_f32 v113, v113, v73
    v_add_f32 v114, v114, v74
    v_add_f32 v115, v115, v75
    v_add_f32 v116, v116, v76
    v_add_f32 v117, v117, v77
    v_add_f32 v118, v118, v78
    v_add_f32 v119, v119, v79
    v_mul_f32 v112, v112, v89
    v_mul_f32 v113, v113, v89
    v_mul_f32 v114, v114, v89
    v_mul_f32 v115, v115, v89
    v_mul_f32 v116, v116, v89
    v_mul_f32 v117, v117, v89
    v_mul_f32 v118, v118, v89
    v_mul_f32 v119, v119, v89
    v_cvt_pk_bf16_f32 v56, v112, v113
    v_cvt_pk_bf16_f32 v57, v114, v115
    v_cvt_pk_bf16_f32 v58, v116, v117
    v_cvt_pk_bf16_f32 v59, v118, v119
    s_nop 0
    v_permlane32_swap_b32 v56, v58
    v_permlane32_swap_b32 v57, v59
    buffer_store_dwordx4 v[56:59], v1, s[8:11], s29 offen sc0 sc1
    s_branch k2_post
k2_cmb2:
    ds_write_b128 v7, v[104:107] offset:2048
    ds_write_b128 v7, v[108:111] offset:3072
    ds_write_b128 v7, v[112:115] offset:10496
    ds_write_b128 v7, v[116:119] offset:11520
    s_mov_b32 exec_lo, 0
    ds_write_b32 v6, v132 offset:512
    s_mov_b32 exec_lo, -1
    ds_write_b128 v7, v[128:131] offset:29440
    ds_write_b128 v7, v[132:135] offset:30464
    s_mov_b64 exec, 1
    ds_add_u32 v160, v161 offset:16
    s_mov_b64 exec, -1
k1_kernel_poll_55:
    ds_read_b32 v4, v160 offset:16
    s_waitcnt lgkmcnt(0)
    v_readfirstlane_b32 s20, v4
    s_cmp_lt_u32 s20, 4
    s_cbranch_scc1 k1_kernel_poll_55
    s_mov_b32 exec_hi, 0
    s_andn2_b32 exec_lo, s6, s7
    buffer_atomic_add v161, v162, s[8:11], s35 offen sc1
    s_mov_b64 exec, -1
    ds_read_b128 v[88:91], v5
    ds_read_b128 v[92:95], v5 offset:512
    ds_read_b128 v[56:59], v7 offset:16896
    ds_read_b128 v[60:63], v7 offset:17920
    ds_read_b128 v[64:67], v7 offset:18944
    ds_read_b128 v[68:71], v7 offset:19968
    ds_read_b128 v[72:75], v7 offset:20992
    ds_read_b128 v[76:79], v7 offset:22016
    s_waitcnt lgkmcnt(6)
    v_add_f32 v88, v88, v89
    v_add_f32 v90, v90, v91
    v_add_f32 v88, v88, v90
    v_add_f32 v92, v92, v93
    v_add_f32 v94, v94, v95
    v_add_f32 v92, v92, v94
    v_rcp_f32 v89, v92
    v_min_f32 v90, v88, v92
    v_add_f32 v93, v88, v92
    s_mov_b32 s20, 0x2b800000
    v_cmp_le_f32 vcc, s20, v90
    s_mov_b32 s20, 0x53800000
    v_cmp_ge_f32 s[30:31], s20, v93
    s_and_b64 vcc, vcc, s[30:31]
    s_cmp_eq_u64 vcc, -1
    s_cselect_b32 s20, 1, s19
    s_cmp_eq_u32 s20, 0
    s_cbranch_scc1 k2_fallback
    s_waitcnt lgkmcnt(4)
    v_add_f32 v120, v120, v56
    v_add_f32 v121, v121, v57
    v_add_f32 v122, v122, v58
    v_add_f32 v123, v123, v59
    v_add_f32 v124, v124, v60
    v_add_f32 v125, v125, v61
    v_add_f32 v126, v126, v62
    v_add_f32 v127, v127, v63
    s_waitcnt lgkmcnt(2)
    v_add_f32 v120, v120, v64
    v_add_f32 v121, v121, v65
    v_add_f32 v122, v122, v66
    v_add_f32 v123, v123, v67
    v_add_f32 v124, v124, v68
    v_add_f32 v125, v125, v69
    v_add_f32 v126, v126, v70
    v_add_f32 v127, v127, v71
    s_waitcnt lgkmcnt(0)
    v_add_f32 v120, v120, v72
    v_add_f32 v121, v121, v73
    v_add_f32 v122, v122, v74
    v_add_f32 v123, v123, v75
    v_add_f32 v124, v124, v76
    v_add_f32 v125, v125, v77
    v_add_f32 v126, v126, v78
    v_add_f32 v127, v127, v79
    v_mul_f32 v120, v120, v89
    v_mul_f32 v121, v121, v89
    v_mul_f32 v122, v122, v89
    v_mul_f32 v123, v123, v89
    v_mul_f32 v124, v124, v89
    v_mul_f32 v125, v125, v89
    v_mul_f32 v126, v126, v89
    v_mul_f32 v127, v127, v89
    v_cvt_pk_bf16_f32 v56, v120, v121
    v_cvt_pk_bf16_f32 v57, v122, v123
    v_cvt_pk_bf16_f32 v58, v124, v125
    v_cvt_pk_bf16_f32 v59, v126, v127
    s_nop 0
    v_permlane32_swap_b32 v56, v58
    v_permlane32_swap_b32 v57, v59
    buffer_store_dwordx4 v[56:59], v1, s[8:11], s29 offen sc0 sc1
    s_branch k2_post
k2_cmb3:
    ds_write_b128 v7, v[104:107] offset:4096
    ds_write_b128 v7, v[108:111] offset:5120
    ds_write_b128 v7, v[112:115] offset:12544
    ds_write_b128 v7, v[116:119] offset:13568
    s_mov_b32 exec_lo, 0
    ds_write_b32 v6, v132 offset:512
    s_mov_b32 exec_lo, -1
    ds_write_b128 v7, v[120:123] offset:20992
    ds_write_b128 v7, v[124:127] offset:22016
    s_mov_b64 exec, 1
    ds_add_u32 v160, v161 offset:16
    s_mov_b64 exec, -1
k1_kernel_poll_56:
    ds_read_b32 v4, v160 offset:16
    s_waitcnt lgkmcnt(0)
    v_readfirstlane_b32 s20, v4
    s_cmp_lt_u32 s20, 4
    s_cbranch_scc1 k1_kernel_poll_56
    s_mov_b32 exec_hi, 0
    s_andn2_b32 exec_lo, s6, s7
    buffer_atomic_add v161, v162, s[8:11], s35 offen sc1
    s_mov_b64 exec, -1
    ds_read_b128 v[88:91], v5
    ds_read_b128 v[92:95], v5 offset:512
    ds_read_b128 v[56:59], v7 offset:25344
    ds_read_b128 v[60:63], v7 offset:26368
    ds_read_b128 v[64:67], v7 offset:27392
    ds_read_b128 v[68:71], v7 offset:28416
    ds_read_b128 v[72:75], v7 offset:29440
    ds_read_b128 v[76:79], v7 offset:30464
    s_waitcnt lgkmcnt(6)
    v_add_f32 v88, v88, v89
    v_add_f32 v90, v90, v91
    v_add_f32 v88, v88, v90
    v_add_f32 v92, v92, v93
    v_add_f32 v94, v94, v95
    v_add_f32 v92, v92, v94
    v_rcp_f32 v89, v92
    v_min_f32 v90, v88, v92
    v_add_f32 v93, v88, v92
    s_mov_b32 s20, 0x2b800000
    v_cmp_le_f32 vcc, s20, v90
    s_mov_b32 s20, 0x53800000
    v_cmp_ge_f32 s[30:31], s20, v93
    s_and_b64 vcc, vcc, s[30:31]
    s_cmp_eq_u64 vcc, -1
    s_cselect_b32 s20, 1, s19
    s_cmp_eq_u32 s20, 0
    s_cbranch_scc1 k2_fallback
    s_waitcnt lgkmcnt(4)
    v_add_f32 v128, v128, v56
    v_add_f32 v129, v129, v57
    v_add_f32 v130, v130, v58
    v_add_f32 v131, v131, v59
    v_add_f32 v132, v132, v60
    v_add_f32 v133, v133, v61
    v_add_f32 v134, v134, v62
    v_add_f32 v135, v135, v63
    s_waitcnt lgkmcnt(2)
    v_add_f32 v128, v128, v64
    v_add_f32 v129, v129, v65
    v_add_f32 v130, v130, v66
    v_add_f32 v131, v131, v67
    v_add_f32 v132, v132, v68
    v_add_f32 v133, v133, v69
    v_add_f32 v134, v134, v70
    v_add_f32 v135, v135, v71
    s_waitcnt lgkmcnt(0)
    v_add_f32 v128, v128, v72
    v_add_f32 v129, v129, v73
    v_add_f32 v130, v130, v74
    v_add_f32 v131, v131, v75
    v_add_f32 v132, v132, v76
    v_add_f32 v133, v133, v77
    v_add_f32 v134, v134, v78
    v_add_f32 v135, v135, v79
    v_mul_f32 v128, v128, v89
    v_mul_f32 v129, v129, v89
    v_mul_f32 v130, v130, v89
    v_mul_f32 v131, v131, v89
    v_mul_f32 v132, v132, v89
    v_mul_f32 v133, v133, v89
    v_mul_f32 v134, v134, v89
    v_mul_f32 v135, v135, v89
    v_cvt_pk_bf16_f32 v56, v128, v129
    v_cvt_pk_bf16_f32 v57, v130, v131
    v_cvt_pk_bf16_f32 v58, v132, v133
    v_cvt_pk_bf16_f32 v59, v134, v135
    s_nop 0
    v_permlane32_swap_b32 v56, v58
    v_permlane32_swap_b32 v57, v59
    buffer_store_dwordx4 v[56:59], v1, s[8:11], s29 offen sc0 sc1
k2_post:
    s_cmp_ge_u32 s3, 4
    s_cbranch_scc1 k2_posty
    s_setprio 0
    s_lshr_b32 s20, s2, 3
    s_mul_i32 s19, s20, 37
    s_lshr_b32 s19, s19, 8
    s_mul_i32 s17, s19, 7
    s_sub_u32 s17, s20, s17
    s_lshr_b32 s21, s17, 2
    s_lshl_b32 s21, s21, 21
    s_and_b32 s22, s17, 3
    s_lshl_b32 s22, s22, 16
    s_add_u32 s21, s21, s22
    s_lshl_b32 s18, s3, 13
    s_add_u32 s21, s21, s18
    s_add_u32 s21, s21, 12320768
    buffer_load_dwordx4 v[8:11], v1, s[8:11], s21 offen sc1
    buffer_load_dwordx4 v[12:15], v1, s[8:11], s21 offen offset:1024 sc1
    buffer_load_dwordx4 v[16:19], v1, s[8:11], s21 offen offset:2048 sc1
    buffer_load_dwordx4 v[20:23], v1, s[8:11], s21 offen offset:3072 sc1
    s_and_b32 s22, s2, 7
    s_lshl_b32 s22, s22, 3
    s_lshr_b32 s23, s19, 1
    s_lshl_b32 s23, s23, 2
    s_add_u32 s22, s22, s23
    s_and_b32 s23, s19, 1
    s_add_u32 s22, s22, s23
    s_lshl_b32 s28, s22, 15
    s_add_u32 s28, s28, s18
    s_add_u32 s28, s28, 6291456
    s_mul_i32 s30, s22, 57344
    s_lshl_b32 s17, s17, 7
    s_add_u32 s30, s30, s17
    s_mov_b32 s12, s36
    s_mov_b32 s13, s37
    s_mov_b32 s14, 3670016
    s_mov_b32 s15, 0x00020000
    v_and_b32 v7, 31, v0
    v_lshlrev_b32 v2, 4, v7
    v_lshrrev_b32 v7, 5, v0
    s_mul_i32 s20, s3, 8448
    s_add_u32 s20, s20, 96512
    v_mul_u32_u24 v7, 528, v7
    v_add3_u32 v2, v2, v7, s20
    s_lshl_b32 s20, s3, 3
    v_lshrrev_b32 v7, 3, v0
    v_add_u32 v7, s20, v7
    v_lshlrev_b32 v3, 4, v7
    v_mul_u32_u24 v5, 1792, v7
    v_and_b32 v7, 7, v0
    v_lshl_add_u32 v5, v7, 4, v5
    v_mul_u32_u24 v7, 1056, v7
    s_mov_b32 s20, 96512
    v_add3_u32 v3, v3, v7, s20
    v_mov_b32 v6, 0
    s_mov_b32 s16, 0
    s_waitcnt vmcnt(4)
    s_mov_b32 exec_hi, 0
    s_mov_b32 exec_lo, s38
    buffer_atomic_add v161, v162, s[8:11], s35 offen sc1
    s_mov_b64 exec, -1
    s_cmp_ge_u32 s2, 224
    s_cbranch_scc1 k2_w8c
    s_add_u32 s21, s21, 4096
    buffer_load_dwordx4 v[24:27], v1, s[8:11], s21 offen sc1
    buffer_load_dwordx4 v[28:31], v1, s[8:11], s21 offen offset:1024 sc1
    buffer_load_dwordx4 v[32:35], v1, s[8:11], s21 offen offset:2048 sc1
    buffer_load_dwordx4 v[36:39], v1, s[8:11], s21 offen offset:3072 sc1
    s_waitcnt vmcnt(5)
    s_add_u32 s21, s21, 28672
    buffer_load_dwordx4 v[40:43], v1, s[8:11], s21 offen sc1
    buffer_load_dwordx4 v[44:47], v1, s[8:11], s21 offen offset:1024 sc1
    buffer_load_dwordx4 v[48:51], v1, s[8:11], s21 offen offset:2048 sc1
    buffer_load_dwordx4 v[52:55], v1, s[8:11], s21 offen offset:3072 sc1
    s_waitcnt vmcnt(4)
    s_add_u32 s21, s21, 4096
    buffer_load_dwordx4 v[56:59], v1, s[8:11], s21 offen sc1
    buffer_load_dwordx4 v[60:63], v1, s[8:11], s21 offen offset:1024 sc1
    buffer_load_dwordx4 v[64:67], v1, s[8:11], s21 offen offset:2048 sc1
    buffer_load_dwordx4 v[68:71], v1, s[8:11], s21 offen offset:3072 sc1
k2_pp:
k1_kernel_pg_57:
    s_sleep 1
    ds_read_b32 v4, v6 offset:80
    s_waitcnt lgkmcnt(0)
    v_readfirstlane_b32 s20, v4
    s_cmp_eq_u32 s20, 0
    s_cbranch_scc1 k1_kernel_pg_57
    v_mov_b32 v7, 0
    s_cmp_lg_u32 s16, 0
    s_cbranch_scc1 k1_kernel_gt_58x
k1_kernel_gt_58:
    s_sleep 2
    ds_read_b32 v4, v7 offset:20
    s_waitcnt lgkmcnt(0)
    v_readfirstlane_b32 s20, v4
    s_cmp_lt_u32 s20, 1
    s_cbranch_scc1 k1_kernel_gt_58
k1_kernel_gt_58x:
    s_add_u32 s29, s28, 4096
    s_mov_b32 s39, 0x2000
k2_rl:
    buffer_load_dwordx4 v[72:75], v1, s[8:11], s28 offen sc1
    buffer_load_dwordx4 v[76:79], v1, s[8:11], s28 offen offset:1024 sc1
    buffer_load_dwordx4 v[80:83], v1, s[8:11], s28 offen offset:2048 sc1
    buffer_load_dwordx4 v[84:87], v1, s[8:11], s28 offen offset:3072 sc1
    buffer_load_dwordx4 v[88:91], v1, s[8:11], s29 offen sc1
    buffer_load_dwordx4 v[92:95], v1, s[8:11], s29 offen offset:1024 sc1
    buffer_load_dwordx4 v[96:99], v1, s[8:11], s29 offen offset:2048 sc1
    buffer_load_dwordx4 v[100:103], v1, s[8:11], s29 offen offset:3072 sc1
    v_mov_b32 v7, 0
k1_kernel_pd_59:
    ds_read_b32 v4, v7 offset:104
    s_waitcnt lgkmcnt(0)
    v_readfirstlane_b32 s20, v4
    s_cmp_lt_u32 s20, s16
    s_cbranch_scc1 k1_kernel_pd_59
    s_waitcnt vmcnt(7)
    v_mfma_f32_32x32x16_bf16 v[104:119], v[8:11], v[72:75], 0
    v_max3_u32 v136, v72, v73, 0
    v_mfma_f32_32x32x16_bf16 v[120:135], v[40:43], v[72:75], 0
    v_max3_u32 v136, v74, v75, v136
    s_waitcnt vmcnt(6)
    v_mfma_f32_32x32x16_bf16 v[104:119], v[12:15], v[76:79], v[104:119]
    v_max3_u32 v136, v76, v77, v136
    v_mfma_f32_32x32x16_bf16 v[120:135], v[44:47], v[76:79], v[120:135]
    v_max3_u32 v136, v78, v79, v136
    s_waitcnt vmcnt(5)
    v_mfma_f32_32x32x16_bf16 v[104:119], v[16:19], v[80:83], v[104:119]
    v_max3_u32 v136, v80, v81, v136
    v_mfma_f32_32x32x16_bf16 v[120:135], v[48:51], v[80:83], v[120:135]
    v_max3_u32 v136, v82, v83, v136
    s_waitcnt vmcnt(4)
    v_mfma_f32_32x32x16_bf16 v[104:119], v[20:23], v[84:87], v[104:119]
    v_max3_u32 v136, v84, v85, v136
    v_mfma_f32_32x32x16_bf16 v[120:135], v[52:55], v[84:87], v[120:135]
    v_max3_u32 v136, v86, v87, v136
    s_waitcnt vmcnt(3)
    v_mfma_f32_32x32x16_bf16 v[104:119], v[24:27], v[88:91], v[104:119]
    v_max3_u32 v136, v88, v89, v136
    v_mfma_f32_32x32x16_bf16 v[120:135], v[56:59], v[88:91], v[120:135]
    v_max3_u32 v136, v90, v91, v136
    s_waitcnt vmcnt(2)
    v_mfma_f32_32x32x16_bf16 v[104:119], v[28:31], v[92:95], v[104:119]
    v_max3_u32 v136, v92, v93, v136
    v_mfma_f32_32x32x16_bf16 v[120:135], v[60:63], v[92:95], v[120:135]
    v_max3_u32 v136, v94, v95, v136
    s_waitcnt vmcnt(1)
    v_mfma_f32_32x32x16_bf16 v[104:119], v[32:35], v[96:99], v[104:119]
    v_max3_u32 v136, v96, v97, v136
    v_mfma_f32_32x32x16_bf16 v[120:135], v[64:67], v[96:99], v[120:135]
    v_max3_u32 v136, v98, v99, v136
    s_waitcnt vmcnt(0)
    v_mfma_f32_32x32x16_bf16 v[104:119], v[36:39], v[100:103], v[104:119]
    v_max3_u32 v136, v100, v101, v136
    v_mfma_f32_32x32x16_bf16 v[120:135], v[68:71], v[100:103], v[120:135]
    v_max3_u32 v136, v102, v103, v136
    v_cmp_eq_u32 vcc, -1, v136
    s_cmp_eq_u64 vcc, 0
    s_cbranch_scc0 k2_rty
k2_rok:
    s_nop 5
    ds_write_b128 v2, v[104:107] offset:0
    ds_write_b128 v2, v[108:111] offset:1056
    ds_write_b128 v2, v[112:115] offset:2112
    ds_write_b128 v2, v[116:119] offset:3168
    ds_write_b128 v2, v[120:123] offset:4224
    ds_write_b128 v2, v[124:127] offset:5280
    ds_write_b128 v2, v[128:131] offset:6336
    ds_write_b128 v2, v[132:135] offset:7392
    s_mov_b64 exec, 1
    ds_add_u32 v6, v161 offset:96
    s_mov_b64 exec, -1
k1_kernel_poll_60:
    ds_read_b32 v4, v6 offset:96
    s_waitcnt lgkmcnt(0)
    v_readfirstlane_b32 s20, v4
    s_cmp_lt_u32 s20, 4
    s_cbranch_scc1 k1_kernel_poll_60
    ds_read_b128 v[72:75], v3 offset:0
    ds_read_b128 v[76:79], v3 offset:528
    ds_read_b128 v[80:83], v3 offset:8448
    ds_read_b128 v[84:87], v3 offset:8976
    ds_read_b128 v[88:91], v3 offset:16896
    ds_read_b128 v[92:95], v3 offset:17424
    ds_read_b128 v[96:99], v3 offset:25344
    ds_read_b128 v[100:103], v3 offset:25872
    s_waitcnt lgkmcnt(4)
    v_add_f32 v72, v72, v80
    v_add_f32 v73, v73, v81
    v_add_f32 v74, v74, v82
    v_add_f32 v75, v75, v83
    v_add_f32 v76, v76, v84
    v_add_f32 v77, v77, v85
    v_add_f32 v78, v78, v86
    v_add_f32 v79, v79, v87
    s_waitcnt lgkmcnt(0)
    v_add_f32 v88, v88, v96
    v_add_f32 v89, v89, v97
    v_add_f32 v90, v90, v98
    v_add_f32 v91, v91, v99
    v_add_f32 v92, v92, v100
    v_add_f32 v93, v93, v101
    v_add_f32 v94, v94, v102
    v_add_f32 v95, v95, v103
    v_add_f32 v72, v72, v88
    v_add_f32 v73, v73, v89
    v_add_f32 v74, v74, v90
    v_add_f32 v75, v75, v91
    v_add_f32 v76, v76, v92
    v_add_f32 v77, v77, v93
    v_add_f32 v78, v78, v94
    v_add_f32 v79, v79, v95
    v_cvt_pk_bf16_f32 v104, v72, v73
    v_cvt_pk_bf16_f32 v105, v74, v75
    v_cvt_pk_bf16_f32 v106, v76, v77
    v_cvt_pk_bf16_f32 v107, v78, v79
    buffer_store_dwordx4 v[104:107], v5, s[12:15], s30 offen sc0 sc1
    s_cmp_lg_u32 s16, 0
    s_cbranch_scc1 k2_pe
    s_mov_b64 exec, 1
    ds_add_u32 v7, v161 offset:104
    s_mov_b64 exec, -1
    s_mov_b32 s16, 4
    v_mov_b32 v6, 4
    s_add_u32 s28, s28, 65536
    s_add_u32 s30, s30, 114688
    s_branch k2_pp
k2_pe:
    s_endpgm
k2_rty:
    s_nop 7
    s_nop 7
    s_sleep 2
    s_sub_u32 s39, s39, 1
    s_cbranch_scc0 k2_rl
    s_branch k2_rok
k2_posty:
    s_lshr_b32 s20, s2, 3
    s_mul_i32 s21, s20, 37
    s_lshr_b32 s21, s21, 8
    s_mul_i32 s22, s21, 7
    s_sub_u32 s20, s20, s22
    s_and_b32 s22, s2, 7
    s_lshl_b32 s22, s22, 2
    s_add_u32 s22, s22, s21
    s_lshl_b32 s22, s22, 1
    s_and_b32 s21, s3, 1
    s_add_u32 s22, s22, s21
    s_bfe_u32 s21, s3, 0x10001
    s_lshl_b32 s20, s20, 1
    s_add_u32 s20, s20, s21
    s_lshl_b32 s21, s21, 2
    v_mov_b32 v6, s21
    s_lshl_b32 s23, s20, 8
    s_bfe_u32 s21, s2, 0x10002
    s_lshl_b32 s21, s21, 7
    s_add_u32 s23, s23, s21
    s_add_u32 s23, s23, 10362880
    s_lshl_b32 s28, s20, 17
    s_lshl_b32 s21, s22, 6
    s_add_u32 s28, s28, s21
    s_add_u32 s28, s28, 12582912
    s_add_u32 s29, s28, 65536
    s_mul_i32 s30, s22, 57344
    s_lshl_b32 s20, s20, 6
    s_add_u32 s30, s30, s20
    s_add_u32 s31, s30, 28672
    s_andn2_b32 s38, s38, 1
    s_waitcnt vmcnt(2)
    s_mov_b32 exec_hi, 0
    s_mov_b32 exec_lo, s38
    buffer_atomic_add v161, v162, s[8:11], s35 offen sc1
    s_mov_b64 exec, -1
    s_cmp_ge_u32 s2, 224
    s_cbranch_scc1 k2_pe
    s_mov_b32 s12, s36
    s_mov_b32 s13, s37
    s_mov_b32 s14, 3670016
    s_mov_b32 s15, 0x00020000
    s_mul_i32 s22, s7, 8448
    s_add_u32 s22, s22, 130304
    v_lshrrev_b32 v5, 2, v0
    v_and_b32 v12, 3, v0
    v_lshlrev_b32 v13, 4, v12
    v_lshl_add_u32 v11, v5, 12, v13
    v_mul_u32_u24 v7, 1792, v5
    v_add_u32 v7, v7, v13
    v_mul_u32_u24 v8, 80, v5
    v_add3_u32 v8, v8, v13, s22
    v_and_b32 v9, 31, v0
    v_mul_u32_u24 v9, 80, v9
    v_lshrrev_b32 v10, 5, v0
    v_lshl_add_u32 v9, v10, 4, v9
    v_add_u32 v9, s22, v9
    v_bfe_u32 v14, v0, 2, 2
    v_lshlrev_b32 v14, 6, v14
    v_lshl_add_u32 v14, v10, 9, v14
    v_lshl_add_u32 v14, v12, 3, v14
    v_bfe_u32 v12, v0, 4, 1
    v_lshl_add_u32 v14, v12, 5, v14
    v_add_u32 v14, s22, v14
    v_add_u32 v15, s22, v1
    s_bitcmp1_b32 s3, 0
    s_cbranch_scc1 k2_yq
    s_mov_b32 s22, 0x40000
    v_mov_b32 v17, 0
    s_mov_b64 exec, 1
k2_yp:
    v_mov_b32 v16, 0
    buffer_atomic_add v16, v17, s[8:11], s23 offen sc0 sc1
    s_sub_u32 s22, s22, 1
    s_cselect_b32 s21, 0, 32
    s_waitcnt vmcnt(0)
    v_readfirstlane_b32 s20, v16
    s_cmp_ge_u32 s20, s21
    s_cbranch_scc1 k2_yr
    s_sleep 2
    s_branch k2_yp
k2_yq:
k1_kernel_poll_61:
    ds_read_b32 v4, v6 offset:88
    s_waitcnt lgkmcnt(0)
    v_readfirstlane_b32 s20, v4
    s_cmp_lt_u32 s20, 1
    s_cbranch_scc1 k1_kernel_poll_61
    s_branch k2_ys
k2_yr:
    ds_write_b32 v6, v161 offset:88
    s_mov_b64 exec, -1
k2_ys:
    buffer_load_dwordx4 v[16:19], v11, s[8:11], s28 offen sc1
    buffer_load_dwordx4 v[20:23], v11, s[8:11], s29 offen sc1
    s_waitcnt vmcnt(1)
    ds_write_b128 v15, v[16:19]
    s_waitcnt vmcnt(0)
    ds_write_b128 v15, v[20:23] offset:1024
    ds_read_b64_tr_b16 v[32:33], v14 offset:0
    ds_read_b64_tr_b16 v[34:35], v14 offset:256
    ds_read_b64_tr_b16 v[36:37], v14 offset:1024
    ds_read_b64_tr_b16 v[38:39], v14 offset:1280
    s_waitcnt lgkmcnt(0)
    ds_write_b128 v9, v[32:35] offset:2048
    ds_write_b128 v9, v[36:39] offset:2080
    ds_read_b128 v[40:43], v8 offset:2048
    ds_read_b128 v[44:47], v8 offset:3328
    s_waitcnt lgkmcnt(1)
    buffer_store_dwordx4 v[40:43], v7, s[12:15], s30 offen offset:896 sc0 sc1
    s_waitcnt lgkmcnt(0)
    buffer_store_dwordx4 v[44:47], v7, s[12:15], s31 offen offset:896 sc0 sc1
    s_endpgm
k2_fallback:
    s_waitcnt vmcnt(0) lgkmcnt(0)
    v_mov_b32 v88, 0xff800000
    v_mov_b32 v89, 0xff800000
    s_mov_b32 s12, s23
    s_mov_b32 s15, 16
k2_fb_lp:
    buffer_load_dwordx4 v[24:27], v1, s[8:11], s12 offen sc1
    buffer_load_dwordx4 v[28:31], v1, s[8:11], s12 offen offset:1024 sc1
    s_waitcnt vmcnt(0)
    v_mfma_f32_32x32x16_bf16 v[56:71], v[24:27], v[8:11], 0
    v_mfma_f32_32x32x16_bf16 v[56:71], v[28:31], v[12:15], v[56:71]
    v_mfma_f32_32x32x16_bf16 v[72:87], v[24:27], v[16:19], 0
    v_mfma_f32_32x32x16_bf16 v[72:87], v[28:31], v[20:23], v[72:87]
    s_nop 9
    v_max3_f32 v88, v88, v56, v57
    v_max3_f32 v88, v88, v58, v59
    v_max3_f32 v88, v88, v60, v61
    v_max3_f32 v88, v88, v62, v63
    v_max3_f32 v88, v88, v64, v65
    v_max3_f32 v88, v88, v66, v67
    v_max3_f32 v88, v88, v68, v69
    v_max3_f32 v88, v88, v70, v71
    v_max3_f32 v89, v89, v72, v73
    v_max3_f32 v89, v89, v74, v75
    v_max3_f32 v89, v89, v76, v77
    v_max3_f32 v89, v89, v78, v79
    v_max3_f32 v89, v89, v80, v81
    v_max3_f32 v89, v89, v82, v83
    v_max3_f32 v89, v89, v84, v85
    v_max3_f32 v89, v89, v86, v87
    s_add_u32 s12, s12, 4096
    s_sub_u32 s15, s15, 1
    s_cmp_lg_u32 s15, 0
    s_cbranch_scc1 k2_fb_lp
    v_mov_b32 v90, v88
    s_nop 1
    v_permlane32_swap_b32 v88, v90
    v_max_f32 v88, v88, v90
    ds_write_b32 v6, v88 offset:2048
    v_mov_b32 v90, v89
    s_nop 1
    v_permlane32_swap_b32 v89, v90
    v_max_f32 v89, v89, v90
    ds_write_b32 v6, v89 offset:2560
    s_mov_b64 exec, 1
    ds_add_u32 v160, v161 offset:24
    s_mov_b64 exec, -1
k1_kernel_poll_62:
    ds_read_b32 v4, v160 offset:24
    s_waitcnt lgkmcnt(0)
    v_readfirstlane_b32 s20, v4
    s_cmp_lt_u32 s20, 4
    s_cbranch_scc1 k1_kernel_poll_62
    ds_read_b128 v[56:59], v5 offset:2048
    ds_read_b128 v[60:63], v5 offset:2560
    s_waitcnt lgkmcnt(0)
    s_mov_b32 exec_lo, 0
    v_max3_f32 v56, v56, v57, v58
    v_max_f32 v56, v56, v59
    v_sub_f32 v56, 0, v56
    v_and_b32 v57, 0xffff0000, v56
    v_sub_f32 v56, v56, v57
    v_and_b32 v58, 0xffff0000, v56
    v_sub_f32 v56, v56, v58
    v_lshrrev_b32 v15, 16, v56
    v_lshrrev_b32 v57, 16, v57
    v_or_b32 v14, v57, v58
    v_max3_f32 v60, v60, v61, v62
    v_max_f32 v60, v60, v63
    v_sub_f32 v60, 0, v60
    v_and_b32 v61, 0xffff0000, v60
    v_sub_f32 v60, v60, v61
    v_and_b32 v62, 0xffff0000, v60
    v_sub_f32 v60, v60, v62
    v_lshrrev_b32 v23, 16, v60
    v_lshrrev_b32 v61, 16, v61
    v_or_b32 v22, v61, v62
    s_mov_b32 exec_lo, -1
    s_mov_b32 s19, 1
    s_mov_b32 s15, 8
    s_mov_b32 s17, 0
    s_mov_b32 s18, 0
    s_add_u32 s12, s23, 4096
    s_add_u32 s13, s23, 8192
    s_add_u32 s14, s23, 12288
    buffer_load_dwordx4 v[24:27], v1, s[8:11], s23 offen sc1
    buffer_load_dwordx4 v[28:31], v1, s[8:11], s23 offen offset:1024 sc1
    buffer_load_dwordx4 v[32:35], v1, s[8:11], s12 offen sc1
    buffer_load_dwordx4 v[36:39], v1, s[8:11], s12 offen offset:1024 sc1
    buffer_load_dwordx4 v[40:43], v1, s[8:11], s23 offen offset:2048 sc1
    buffer_load_dwordx4 v[44:47], v1, s[8:11], s23 offen offset:3072 sc1
    s_waitcnt vmcnt(0)
    s_branch k2_restart
k2_ld:
    s_barrier
k2_ld_nb:
    v_mov_b32 v131, 1
    buffer_atomic_add v131, v130, s[16:19], 0 offen sc1
    v_lshlrev_b32 v1, 4, v0
    s_load_dwordx2 s[24:25], s[0:1], 112
    s_load_dwordx2 s[40:41], s[0:1], 96
    s_setprio 3
    s_and_b32 s4, s2, 7
    s_lshl_b32 s4, s4, 1
    s_lshr_b32 s20, s2, 7
    s_add_u32 s4, s4, s20
    s_bfe_u32 s5, s2, 0x20005
    s_lshl_b32 s21, s4, 9
    s_add_u32 s21, s21, 10371072
    v_lshl_add_u32 v132, v0, 7, s21
    s_lshr_b32 s20, s2, 4
    s_lshl_b32 s20, s20, 7
    s_add_u32 s20, s20, 10379264
    v_writelane_b32 v132, s20, 4
    s_mov_b32 s20, 357832020
    s_lshl_b32 s21, s4, 1
    s_lshr_b32 s20, s20, s21
    s_and_b32 s20, s20, 3
    s_lshl_b32 s20, s20, 2
    s_add_u32 s20, s20, 12
    v_mov_b32 v133, s20
    s_cmp_lt_u32 s2, 224
    s_cselect_b32 s20, 64, 0
    v_writelane_b32 v133, s20, 4
    v_lshlrev_b32 v134, 2, v0
    v_mov_b32 v152, 0
    v_mov_b32 v153, 0
    v_mov_b32 v154, 0
    v_mov_b32 v155, 0
    v_add_u32 v5, 0, v0
    v_mul_u32_u24 v6, 52429, v5
    v_lshrrev_b32 v6, 18, v6
    v_mul_u32_u24 v7, 5, v6
    v_sub_u32 v5, v5, v7
    v_min_u32 v5, 3, v5
    v_lshlrev_b32 v5, 4, v5
    v_lshl_add_u32 v8, v6, 6, v5
    v_add_u32 v5, 64, v0
    v_mul_u32_u24 v6, 52429, v5
    v_lshrrev_b32 v6, 18, v6
    v_mul_u32_u24 v7, 5, v6
    v_sub_u32 v5, v5, v7
    v_min_u32 v5, 3, v5
    v_lshlrev_b32 v5, 4, v5
    v_lshl_add_u32 v9, v6, 6, v5
    v_add_u32 v5, 128, v0
    v_mul_u32_u24 v6, 52429, v5
    v_lshrrev_b32 v6, 18, v6
    v_mul_u32_u24 v7, 5, v6
    v_sub_u32 v5, v5, v7
    v_min_u32 v5, 3, v5
    v_lshlrev_b32 v5, 4, v5
    v_lshl_add_u32 v10, v6, 6, v5
    v_add_u32 v5, 192, v0
    v_mul_u32_u24 v6, 52429, v5
    v_lshrrev_b32 v6, 18, v6
    v_mul_u32_u24 v7, 5, v6
    v_sub_u32 v5, v5, v7
    v_min_u32 v5, 3, v5
    v_lshlrev_b32 v5, 4, v5
    v_lshl_add_u32 v11, v6, 6, v5
    v_add_u32 v5, 256, v0
    v_mul_u32_u24 v6, 52429, v5
    v_lshrrev_b32 v6, 18, v6
    v_mul_u32_u24 v7, 5, v6
    v_sub_u32 v5, v5, v7
    v_min_u32 v5, 3, v5
    v_lshlrev_b32 v5, 4, v5
    v_lshl_add_u32 v12, v6, 6, v5
    s_mul_i32 s29, s2, 8448
    s_add_u32 s29, s29, 8388608
    s_lshl_b32 s30, s2, 13
    s_add_u32 s30, s30, 10485760
    s_and_b32 s31, s2, 7
    s_lshl_b32 s31, s31, 5
    s_lshr_b32 s20, s2, 3
    s_add_u32 s31, s31, s20
    s_lshl_b32 s31, s31, 14
    s_add_u32 s31, s31, 2097152
    v_lshlrev_b32 v14, 7, v0
    s_waitcnt lgkmcnt(0)
    s_mov_b32 s8, s24
    s_mov_b32 s9, s25
    s_mov_b32 s10, 14680064
    s_mov_b32 s11, 0x00020000
    s_mov_b32 s22, 0x8000
    s_mov_b32 s46, 0
    s_mov_b32 exec_hi, 0
    ds_write_b128 v1, v[152:155] offset:39680
    ds_write_b128 v1, v[152:155] offset:47360
    s_mov_b32 exec_hi, -1
    ds_write_b128 v1, v[152:155] offset:37632
    ds_write_b128 v1, v[152:155] offset:38656
    ds_write_b128 v1, v[152:155] offset:45312
    ds_write_b128 v1, v[152:155] offset:46336
    s_mov_b32 exec_hi, 0
    s_andn2_b32 exec_lo, 31, s46
    v_mov_b32 v140, 0
    buffer_atomic_add v140, v132, s[16:19], 0 offen sc0 sc1
    s_sleep 8
k2_hp:
    s_mov_b32 s47, exec_lo
    s_andn2_b32 exec_lo, 31, s46
    v_mov_b32 v144, 0
    buffer_atomic_add v144, v132, s[16:19], 0 offen sc0 sc1
    s_mov_b32 s48, exec_lo
    s_sub_u32 s22, s22, 1
    s_cselect_b32 s52, 31, 0
    s_mov_b32 exec_lo, s47
    s_waitcnt vmcnt(1)
    v_cmp_le_u32 vcc, v133, v140
    s_or_b32 s46, s46, vcc_lo
    s_or_b32 s46, s46, s52
    s_bitcmp1_b32 s46, s5
    s_cselect_b32 s20, s46, 0
    s_and_b32 exec_lo, s20, 15
    ds_write_b32 v134, v131 offset:112
    s_cmp_eq_u32 s46, 31
    s_cbranch_scc1 k2_hq
    s_sleep 8
    s_andn2_b32 exec_lo, 31, s46
    v_mov_b32 v140, 0
    buffer_atomic_add v140, v132, s[16:19], 0 offen sc0 sc1
    s_mov_b32 s47, exec_lo
    s_mov_b32 exec_lo, s48
    s_waitcnt vmcnt(1)
    v_cmp_le_u32 vcc, v133, v144
    s_or_b32 s46, s46, vcc_lo
    s_or_b32 s46, s46, s52
    s_bitcmp1_b32 s46, s5
    s_cselect_b32 s20, s46, 0
    s_and_b32 exec_lo, s20, 15
    ds_write_b32 v134, v131 offset:112
    s_cmp_eq_u32 s46, 31
    s_mov_b32 exec_lo, s47
    s_cbranch_scc1 k2_hq
    s_sleep 8
    s_branch k2_hp
k2_hq:
    s_mov_b64 exec, -1
    s_cmp_ge_u32 s2, 224
    s_cbranch_scc1 k2_ldpf
    v_mov_b32 v5, 0
k1_kernel_poll_63:
    ds_read_b32 v4, v5 offset:8
    s_waitcnt lgkmcnt(0)
    v_readfirstlane_b32 s20, v4
    s_cmp_lt_u32 s20, 1
    s_cbranch_scc1 k1_kernel_poll_63
    s_mov_b32 m0, 40192
    s_add_u32 s20, s30, 0
    s_nop 0
    buffer_load_dwordx4 v8, s[8:11], s20 offen sc1 lds
    s_mov_b32 m0, 41216
    s_add_u32 s20, s30, 0
    buffer_load_dwordx4 v9, s[8:11], s20 offen sc1 lds
    s_mov_b32 m0, 42240
    s_add_u32 s20, s30, 0
    buffer_load_dwordx4 v10, s[8:11], s20 offen sc1 lds
    s_mov_b32 m0, 43264
    s_add_u32 s20, s30, 0
    buffer_load_dwordx4 v11, s[8:11], s20 offen sc1 lds
    s_mov_b32 m0, 44288
    s_add_u32 s20, s30, 0
    buffer_load_dwordx4 v12, s[8:11], s20 offen sc1 lds
    s_mov_b32 m0, 47872
    s_add_u32 s20, s30, 4096
    buffer_load_dwordx4 v8, s[8:11], s20 offen sc1 lds
    s_mov_b32 m0, 48896
    s_add_u32 s20, s30, 4096
    buffer_load_dwordx4 v9, s[8:11], s20 offen sc1 lds
    s_mov_b32 m0, 49920
    s_add_u32 s20, s30, 4096
    buffer_load_dwordx4 v10, s[8:11], s20 offen sc1 lds
    s_mov_b32 m0, 50944
    s_add_u32 s20, s30, 4096
    buffer_load_dwordx4 v11, s[8:11], s20 offen sc1 lds
    s_mov_b32 m0, 51968
    s_add_u32 s20, s30, 4096
    buffer_load_dwordx4 v12, s[8:11], s20 offen sc1 lds
    v_mov_b32 v5, 0
    v_mov_b32 v6, 1
    s_waitcnt vmcnt(0) lgkmcnt(0)
    s_mov_b64 exec, 1
    ds_add_u32 v5, v6 offset:0
    s_mov_b64 exec, -1
k2_ldpf:
    s_mov_b32 s42, 3670016
    s_mov_b32 s43, 0x00020000
    s_lshr_b32 s20, s2, 3
    s_lshr_b32 s21, s20, 4
    s_lshl_b32 s21, s21, 21
    s_and_b32 s22, s20, 15
    s_lshl_b32 s22, s22, 14
    s_add_u32 s21, s21, s22
    s_add_u32 s21, s21, 12320768
    s_add_u32 s22, s21, 8192
    v_lshlrev_b32 v5, 7, v0
    buffer_load_dword v16, v5, s[8:11], s21 offen
    buffer_load_dword v17, v5, s[8:11], s22 offen
    s_cmp_lt_u32 s2, 224
    s_cbranch_scc1 k2_pfs
    v_lshlrev_b32 v7, 16, v0
    buffer_load_dword v18, v7, s[40:43], 0 offen
k2_pfs:
    s_cmp_ge_u32 s2, 224
    s_cbranch_scc1 k2_w8c
    s_and_b32 s21, s2, 7
    s_mul_i32 s19, s20, 37
    s_lshr_b32 s19, s19, 8
    s_lshr_b32 s22, s19, 1
    s_lshl_b32 s22, s22, 2
    s_and_b32 s23, s19, 1
    s_add_u32 s22, s22, s23
    s_lshl_b32 s23, s21, 3
    s_add_u32 s22, s22, s23
    s_lshl_b32 s22, s22, 7
    v_lshl_add_u32 v5, v0, 8, s22
    s_mul_i32 s22, s19, 7
    s_sub_u32 s22, s20, s22
    s_lshl_b32 s22, s22, 2
    s_lshr_b32 s21, s21, 2
    s_add_u32 s22, s22, s21
    s_lshl_b32 s22, s22, 7
    s_add_u32 s22, s22, 8192
    v_writelane_b32 v5, s22, 2
    s_add_u32 s22, s22, 256
    v_writelane_b32 v5, s22, 3
    v_lshlrev_b32 v7, 2, v0
    v_mov_b32 v8, 1
    v_mov_b32 v6, 0
k2_w8a:
    s_sleep 4
    ds_read_b32 v9, v6 offset:68
    s_waitcnt lgkmcnt(0)
    v_readfirstlane_b32 s20, v9
    s_cmp_lt_u32 s20, 3
    s_cbranch_scc1 k2_w8a
    s_mov_b32 s21, 10354688
    s_mov_b32 s22, 0x40000
    v_mov_b32 v11, 32
    v_writelane_b32 v11, 16, 1
    s_mov_b64 exec, 3
    s_mov_b64 exec, 1
k2_w8e:
    v_mov_b32 v9, 0
    buffer_atomic_add v9, v5, s[8:11], s21 offen sc0 sc1
    s_sub_u32 s22, s22, 1
    s_cselect_b32 s23, 0, -1
    s_waitcnt vmcnt(0)
    s_mov_b64 s[26:27], exec
    v_and_b32 v11, s23, v11
    v_cmp_le_u32 vcc, v11, v9
    s_mov_b64 exec, vcc
    ds_write_b32 v7, v8 offset:80
    s_andn2_b64 exec, s[26:27], vcc
    s_cbranch_scc0 k2_w8f
    s_sleep 4
    s_branch k2_w8e
k2_w8f:
    s_mov_b64 exec, 2
k2_w8g:
    s_sleep 2
    ds_read_b32 v9, v6 offset:20
    s_waitcnt lgkmcnt(0)
    v_readfirstlane_b32 s20, v9
    s_cmp_lt_u32 s20, 4
    s_cbranch_scc1 k2_w8g
    v_mov_b32 v9, 0
    buffer_atomic_add v9, v5, s[8:11], s21 offen sc0 sc1
    s_sleep 5
k2_w8b:
    v_mov_b32 v10, 0
    buffer_atomic_add v10, v5, s[8:11], s21 offen sc0 sc1
    s_sub_u32 s22, s22, 1
    s_cselect_b32 s23, 0, -1
    s_waitcnt vmcnt(1)
    s_mov_b64 s[26:27], exec
    v_and_b32 v11, s23, v11
    v_cmp_le_u32 vcc, v11, v9
    s_mov_b64 exec, vcc
    ds_write_b32 v7, v8 offset:80
    s_andn2_b64 exec, s[26:27], vcc
    s_cbranch_scc0 k2_w8c
    v_mov_b32 v9, 0
    buffer_atomic_add v9, v5, s[8:11], s21 offen sc0 sc1
    s_waitcnt vmcnt(1)
    s_mov_b64 s[26:27], exec
    v_and_b32 v11, s23, v11
    v_cmp_le_u32 vcc, v11, v10
    s_mov_b64 exec, vcc
    ds_write_b32 v7, v8 offset:80
    s_andn2_b64 exec, s[26:27], vcc
    s_cbranch_scc1 k2_w8b
k2_w8c:
    s_mov_b64 exec, -1
    s_waitcnt vmcnt(0) lgkmcnt(0)
    s_endpgm
k2_end:
    s_endpgm
.section .rodata,"a"
.p2align 6
.amdhsa_kernel concat_heads__mha_block__ssm_conv_s4__prompt_kernel
  .amdhsa_next_free_vgpr 168
  .amdhsa_next_free_sgpr 102
  .amdhsa_accum_offset 168
  .amdhsa_group_segment_fixed_size 0
  .amdhsa_kernarg_size 120
  .amdhsa_user_sgpr_count 2
  .amdhsa_user_sgpr_kernarg_segment_ptr 1
  .amdhsa_system_sgpr_workgroup_id_x 1
.end_amdhsa_kernel
```
